```python
import torch

def _softmax(x, axis=-1):
    return torch.softmax(x, dim=axis)

def _gelu(x):
    return torch.nn.functional.gelu(x, approximate='tanh')

def _silu(x):
    return torch.nn.functional.silu(x)

def _sigmoid(x):
    return torch.sigmoid(x)

def _layernorm(x, axis=-1, eps=1e-05):
    m = x.mean(dim=axis, keepdim=True)
    v = x.var(dim=axis, keepdim=True, unbiased=False)
    return (x - m) / torch.sqrt(v + eps)

def _scatter_add(tgt, idx, src, axis=0):
    return tgt.clone().index_add_(axis, idx, src)

def _segment_sum(src, seg, n):
    out = torch.zeros((n,) + src.shape[1:], dtype=src.dtype)
    return out.index_add_(0, seg, src)

def _pad(x, pw):
    flat = tuple((v for pair in reversed(pw) for v in pair))
    return torch.nn.functional.pad(x, flat)
kernel_name = 'recurrent_scan__spectral_fnet__mixer_gmlp__prompt'

def setup_inputs():

    _w = lambda a: (lambda t: t.to(torch.bfloat16) if t.is_floating_point() else t)(torch.as_tensor(a))

    def _A_setup():
        B, S, D = (1, 2048, 512)
        ns = torch.arange(S)[:, None] * torch.arange(S)[None, :]
        nd = torch.arange(D)[:, None] * torch.arange(D)[None, :]
        Ws_re = torch.cos(-2.0 * torch.pi * ns / S).to(float)
        Ws_im = torch.sin(-2.0 * torch.pi * ns / S).to(float)
        Wd_re = torch.cos(-2.0 * torch.pi * nd / D).to(float)
        Wd_im = torch.sin(-2.0 * torch.pi * nd / D).to(float)
        return {'x': _w((lambda *s: torch.randn(*s, dtype=torch.bfloat16) * 0.05)(B, S, D)), 'dft_seq_re': _w(Ws_re), 'dft_seq_im': _w(Ws_im), 'dft_hid_re': _w(Wd_re), 'dft_hid_im': _w(Wd_im)}
    _A_in = _A_setup()

    def _B_setup():
        B, S, D, F = (1, 2048, 512, 1376)
        Fh = F // 2
        return {'x': _w((lambda *s: torch.randn(*s, dtype=torch.bfloat16) * 0.05)(B, S, D)), 'w_in': _w((lambda *s: torch.randn(*s, dtype=torch.bfloat16) * 0.4)(D, 2 * Fh)), 'w_sp': _w(0.01 * (lambda *s: torch.randn(*s, dtype=torch.bfloat16) * 0.4)(S, S)), 'b_sp': _w(1.0 + 0.01 * (lambda *s: torch.randn(*s, dtype=torch.bfloat16) * 0.05)(S)), 'w_out': _w((lambda *s: torch.randn(*s, dtype=torch.bfloat16) * 0.05)(Fh, D))}
    _B_in = _B_setup()
    return {'A_x': _A_in['x'], 'A_dft_seq_re': _A_in['dft_seq_re'], 'A_dft_seq_im': _A_in['dft_seq_im'], 'A_dft_hid_re': _A_in['dft_hid_re'], 'A_dft_hid_im': _A_in['dft_hid_im'], 'B_x': _B_in['x'], 'B_w_in': _B_in['w_in'], 'B_w_sp': _B_in['w_sp'], 'B_b_sp': _B_in['b_sp'], 'B_w_out': _B_in['w_out']}

def reference(A_x, A_dft_seq_re, A_dft_seq_im, A_dft_hid_re, A_dft_hid_im, B_x, B_w_in, B_w_sp, B_b_sp, B_w_out):

    def _A_ref(x, dft_seq_re, dft_seq_im, dft_hid_re, dft_hid_im):
        a = torch.einsum('bsd,ed->bse', x, dft_hid_re)
        b = torch.einsum('bsd,ed->bse', x, dft_hid_im)
        y = torch.einsum('ts,bse->bte', dft_seq_re, a) - torch.einsum('ts,bse->bte', dft_seq_im, b)
        return y

    def _B_ref(x, w_in, w_sp, b_sp, w_out):
        B, S, D = x.shape
        F = w_in.shape[-1]
        Fh = F // 2
        z = _gelu(torch.einsum('bsd,df->bsf', x, w_in))
        z1 = z[..., :Fh].clone()
        z2 = _layernorm(z[..., Fh:], axis=-1)
        g = torch.einsum('ts,bsf->btf', w_sp, z2) + b_sp[None, :, None]
        return torch.einsum('bsf,fd->bsd', z1 * g, w_out)
    x = A_x
    xn = _layernorm(x, axis=-1)
    s = _A_ref(xn, A_dft_seq_re, A_dft_seq_im, A_dft_hid_re, A_dft_hid_im)
    g = _silu(_B_ref(xn, B_w_in, B_w_sp, B_b_sp, B_w_out))
    return x + s * g
```

```asm
; @launch grid=(256,1,1) block=(512,1,1) lds=163840
.amdgcn_target "amdgcn-amd-amdhsa--gfx950"
.text
.globl recurrent_scan__spectral_fnet__mixer_gmlp__prompt_kernel
.p2align 8
.type recurrent_scan__spectral_fnet__mixer_gmlp__prompt_kernel,@function
recurrent_scan__spectral_fnet__mixer_gmlp__prompt_kernel:
  s_cmp_ge_u32 s2, 256
  s_cbranch_scc1 L_end
  s_load_dwordx16 s[64:79], s[0:1], 0
  s_load_dwordx8 s[80:87], s[0:1], 64
  s_load_dwordx2 s[88:89], s[0:1], 96
  s_and_b32 s44, s2, 7
  s_lshl_b32 s44, s44, 2
  s_bfe_u32 s3, s2, 0x20003
  s_add_u32 s44, s44, s3
  s_lshr_b32 s45, s2, 5
  s_lshl_b32 s50, s45, 5
  s_add_u32 s50, s50, s44
  v_lshrrev_b32 v5, 6, v0
  v_and_b32 v1, 63, v0
  v_readfirstlane_b32 s46, v5
  v_lshrrev_b32 v20, 3, v0
  v_and_b32 v21, 7, v0
  v_lshlrev_b32 v22, 10, v20
  v_lshl_add_u32 v22, v21, 4, v22
  s_lshl_b32 s90, s44, 16
  s_and_b32 s58, s46, 3
  v_and_b32 v2, 31, v0
  v_bfe_u32 v3, v0, 5, 1
  v_and_b32 v5, 0x13, v2
  v_and_b32 v6, 4, v2
  v_lshl_or_b32 v5, v6, 1, v5
  v_and_b32 v6, 8, v2
  v_lshrrev_b32 v6, 1, v6
  v_or_b32 v4, v5, v6
  s_mul_i32 s47, s45, 88
  s_cmp_eq_u32 s45, 7
  s_cselect_b32 s3, 8, 0
  s_sub_u32 s47, s47, s3
  s_cmp_ge_u32 s45, 6
  s_cselect_b32 s3, 8, 0
  s_sub_u32 s48, 88, s3
  v_mov_b32 v10, 0
  v_mov_b32 v11, 0
  v_mov_b32 v12, 0
  v_mov_b32 v13, 0
  s_waitcnt lgkmcnt(0)
  s_mov_b32 s4, s64
  s_and_b32 s5, s65, 0xffff
  s_mov_b32 s6, 0x200000
  s_mov_b32 s7, 0x20000
  s_and_b32 s59, s44, 3
  s_lshl_b32 s59, s59, 1
  s_add_u32 s59, s59, s45
  s_and_b32 s59, s59, 7
  s_mov_b32 s59, 0
  s_add_u32 s3, s59, 0
  s_and_b32 s3, s3, 7
  s_lshl_b32 s3, s3, 7
  s_add_u32 s3, s3, s90
  buffer_load_dwordx4 v[32:35], v22, s[4:7], s3 offen
  s_add_u32 s3, s59, 1
  s_and_b32 s3, s3, 7
  s_lshl_b32 s3, s3, 7
  s_add_u32 s3, s3, s90
  buffer_load_dwordx4 v[36:39], v22, s[4:7], s3 offen
  s_add_u32 s3, s59, 2
  s_and_b32 s3, s3, 7
  s_lshl_b32 s3, s3, 7
  s_add_u32 s3, s3, s90
  buffer_load_dwordx4 v[40:43], v22, s[4:7], s3 offen
  s_add_u32 s3, s59, 3
  s_and_b32 s3, s3, 7
  s_lshl_b32 s3, s3, 7
  s_add_u32 s3, s3, s90
  buffer_load_dwordx4 v[44:47], v22, s[4:7], s3 offen
  s_add_u32 s3, s59, 4
  s_and_b32 s3, s3, 7
  s_lshl_b32 s3, s3, 7
  s_add_u32 s3, s3, s90
  buffer_load_dwordx4 v[48:51], v22, s[4:7], s3 offen
  s_add_u32 s3, s59, 5
  s_and_b32 s3, s3, 7
  s_lshl_b32 s3, s3, 7
  s_add_u32 s3, s3, s90
  buffer_load_dwordx4 v[52:55], v22, s[4:7], s3 offen
  s_add_u32 s3, s59, 6
  s_and_b32 s3, s3, 7
  s_lshl_b32 s3, s3, 7
  s_add_u32 s3, s3, s90
  buffer_load_dwordx4 v[56:59], v22, s[4:7], s3 offen
  s_add_u32 s3, s59, 7
  s_and_b32 s3, s3, 7
  s_lshl_b32 s3, s3, 7
  s_add_u32 s3, s3, s90
  buffer_load_dwordx4 v[60:63], v22, s[4:7], s3 offen
  s_mov_b32 s8, s76
  s_and_b32 s9, s77, 0xffff
  s_mov_b32 s10, 0x158000
  s_mov_b32 s11, 0x20000
  s_mov_b32 s12, s70
  s_and_b32 s13, s71, 0xffff
  s_mov_b32 s14, 0x80000
  s_mov_b32 s15, 0x20000
  s_mov_b32 s16, s72
  s_and_b32 s17, s73, 0xffff
  s_mov_b32 s18, 0x80000
  s_mov_b32 s19, 0x20000
  s_mov_b32 s28, s88
  s_and_b32 s29, s89, 0xffff
  s_mov_b32 s30, 0x4000000
  s_mov_b32 s31, 0x20000
  s_mov_b32 s40, s86
  s_and_b32 s41, s87, 0xffff
  s_mov_b32 s42, 0x100
  s_mov_b32 s43, 0x20000
  s_mov_b32 s20, s78
  s_and_b32 s21, s79, 0xffff
  s_mov_b32 s22, 0x800000
  s_mov_b32 s23, 0x20000
  s_mov_b32 s24, s82
  s_and_b32 s25, s83, 0xffff
  s_mov_b32 s26, 0xac000
  s_mov_b32 s27, 0x20000
  s_mov_b32 s32, s84
  s_and_b32 s33, s85, 0xffff
  s_mov_b32 s34, 0x200000
  s_mov_b32 s35, 0x20000
  s_mov_b32 s36, s80
  s_and_b32 s37, s81, 0xffff
  s_mov_b32 s38, 0x1000
  s_mov_b32 s39, 0x20000
  s_cmp_lt_u32 s46, 4
  s_cbranch_scc0 L_pro_h
  s_branch L_pro_c
L_pro_h:
  v_lshrrev_b32 v5, 3, v1
  v_and_b32 v6, 7, v1
  v_lshrrev_b32 v7, 4, v1
  v_xor_b32 v8, v6, v7
  v_lshlrev_b32 v8, 4, v8
  s_lshl_b32 s3, s45, 5
  s_lshl_b32 s63, s58, 3
  s_add_u32 s3, s3, s63
  v_add_u32 v9, s3, v5
  v_cmp_eq_u32 vcc, 0, v9
  v_mov_b32 v6, 256
  s_nop 0
  v_cndmask_b32 v9, v9, v6, vcc
  s_and_b32 s63, s58, 1
  s_lshl_b32 s63, s63, 6
  v_xor_b32 v8, s63, v8
  v_lshl_add_u32 v10, v9, 10, v8
  v_add_u32 v5, 0, v1
  v_mul_u32_u24 v6, 171, v5
  v_lshrrev_b32 v6, 11, v6
  v_mul_u32_u24 v7, 12, v6
  v_sub_u32 v7, v5, v7
  v_mul_u32_u24 v6, 2752, v6
  v_lshl_add_u32 v6, v7, 4, v6
  v_lshlrev_b32 v7, 3, v7
  v_cmp_gt_u32 vcc, s48, v7
  v_mov_b32 v8, 0x80000000
  s_nop 0
  v_cndmask_b32 v11, v8, v6, vcc
  v_add_u32 v5, 64, v1
  v_mul_u32_u24 v6, 171, v5
  v_lshrrev_b32 v6, 11, v6
  v_mul_u32_u24 v7, 12, v6
  v_sub_u32 v7, v5, v7
  v_mul_u32_u24 v6, 2752, v6
  v_lshl_add_u32 v6, v7, 4, v6
  v_lshlrev_b32 v7, 3, v7
  v_cmp_gt_u32 vcc, s48, v7
  v_mov_b32 v8, 0x80000000
  s_nop 0
  v_cndmask_b32 v12, v8, v6, vcc
  v_add_u32 v5, 128, v1
  v_mul_u32_u24 v6, 171, v5
  v_lshrrev_b32 v6, 11, v6
  v_mul_u32_u24 v7, 12, v6
  v_sub_u32 v7, v5, v7
  v_mul_u32_u24 v6, 2752, v6
  v_lshl_add_u32 v6, v7, 4, v6
  v_lshlrev_b32 v7, 3, v7
  v_cmp_gt_u32 vcc, s48, v7
  v_mov_b32 v8, 0x80000000
  s_nop 0
  v_cndmask_b32 v13, v8, v6, vcc
  s_lshl_b32 s60, s58, 10
  s_mul_i32 s61, s58, 3072
  s_mul_i32 s62, s58, 44032
  s_lshl_b32 s3, s47, 1
  s_add_u32 s62, s62, s3
  s_add_u32 s56, s62, 1376
  s_add_u32 s90, s59, 0
  s_and_b32 s90, s90, 7
  s_add_u32 m0, s60, 77824
  s_lshl_b32 s63, s90, 7
  buffer_load_dwordx4 v10, s[12:15], s63 offen lds
  s_mul_i32 s90, s90, 176128
  s_add_u32 m0, s61, 65536
  s_add_u32 s63, s56, s90
  buffer_load_dwordx4 v11, s[8:11], s63 offen lds
  s_add_u32 m0, m0, 1024
  s_nop 0
  buffer_load_dwordx4 v12, s[8:11], s63 offen lds
  s_add_u32 m0, m0, 1024
  s_nop 0
  buffer_load_dwordx4 v13, s[8:11], s63 offen lds
  s_add_u32 s90, s59, 1
  s_and_b32 s90, s90, 7
  s_add_u32 m0, s60, 94208
  s_lshl_b32 s63, s90, 7
  buffer_load_dwordx4 v10, s[12:15], s63 offen lds
  s_mul_i32 s90, s90, 176128
  s_add_u32 m0, s61, 81920
  s_add_u32 s63, s56, s90
  buffer_load_dwordx4 v11, s[8:11], s63 offen lds
  s_add_u32 m0, m0, 1024
  s_nop 0
  buffer_load_dwordx4 v12, s[8:11], s63 offen lds
  s_add_u32 m0, m0, 1024
  s_nop 0
  buffer_load_dwordx4 v13, s[8:11], s63 offen lds
  s_add_u32 s90, s59, 2
  s_and_b32 s90, s90, 7
  s_add_u32 m0, s60, 110592
  s_lshl_b32 s63, s90, 7
  buffer_load_dwordx4 v10, s[12:15], s63 offen lds
  s_mul_i32 s90, s90, 176128
  s_add_u32 m0, s61, 98304
  s_add_u32 s63, s56, s90
  buffer_load_dwordx4 v11, s[8:11], s63 offen lds
  s_add_u32 m0, m0, 1024
  s_nop 0
  buffer_load_dwordx4 v12, s[8:11], s63 offen lds
  s_add_u32 m0, m0, 1024
  s_nop 0
  buffer_load_dwordx4 v13, s[8:11], s63 offen lds
  s_add_u32 s90, s59, 3
  s_and_b32 s90, s90, 7
  s_add_u32 m0, s60, 126976
  s_lshl_b32 s63, s90, 7
  buffer_load_dwordx4 v10, s[12:15], s63 offen lds
  s_mul_i32 s90, s90, 176128
  s_add_u32 m0, s61, 114688
  s_add_u32 s63, s56, s90
  buffer_load_dwordx4 v11, s[8:11], s63 offen lds
  s_add_u32 m0, m0, 1024
  s_nop 0
  buffer_load_dwordx4 v12, s[8:11], s63 offen lds
  s_add_u32 m0, m0, 1024
  s_nop 0
  buffer_load_dwordx4 v13, s[8:11], s63 offen lds
  s_cmp_lg_u32 s2, 0
  s_cbranch_scc1 L_nononce
  s_cmp_lg_u32 s46, 4
  s_cbranch_scc1 L_nononce
  s_memrealtime s[100:101]
  s_waitcnt lgkmcnt(0)
  s_or_b32 s3, s100, 1
  v_mov_b32 v5, s3
  v_mov_b32 v6, 0
  s_mov_b64 exec, 1
  buffer_store_dword v5, v6, s[40:43], 0 offen sc1
  s_mov_b64 exec, -1
L_nononce:
  v_lshlrev_b32 v5, 2, v1
  v_add_u32 v5, 149504, v5
  v_mov_b32 v6, 0
  s_mov_b64 exec, 0xffff
  ds_write_b32 v5, v6
  s_mov_b64 exec, -1
L_pro_c:
  v_mov_b32 v23, 0x3f803f80
  v_mov_b32 v24, 0
  v_mov_b32 v25, 0
  v_mov_b32 v26, 0
  v_mov_b32 v27, 0
  v_bfe_u32 v5, v20, 1, 3
  v_xor_b32 v5, v5, v21
  v_lshlrev_b32 v5, 4, v5
  v_lshl_add_u32 v28, v20, 7, v5
  s_cmp_lt_u32 s46, 4
  s_cbranch_scc1 L_xw_c
  s_waitcnt vmcnt(23)
  v_dot2c_f32_bf16 v24, v32, v23
  v_dot2c_f32_bf16 v26, v32, v32
  v_dot2c_f32_bf16 v25, v33, v23
  v_dot2c_f32_bf16 v27, v33, v33
  v_dot2c_f32_bf16 v24, v34, v23
  v_dot2c_f32_bf16 v26, v34, v34
  v_dot2c_f32_bf16 v25, v35, v23
  v_dot2c_f32_bf16 v27, v35, v35
  s_waitcnt vmcnt(22)
  v_dot2c_f32_bf16 v24, v36, v23
  v_dot2c_f32_bf16 v26, v36, v36
  v_dot2c_f32_bf16 v25, v37, v23
  v_dot2c_f32_bf16 v27, v37, v37
  v_dot2c_f32_bf16 v24, v38, v23
  v_dot2c_f32_bf16 v26, v38, v38
  v_dot2c_f32_bf16 v25, v39, v23
  v_dot2c_f32_bf16 v27, v39, v39
  s_waitcnt vmcnt(21)
  v_dot2c_f32_bf16 v24, v40, v23
  v_dot2c_f32_bf16 v26, v40, v40
  v_dot2c_f32_bf16 v25, v41, v23
  v_dot2c_f32_bf16 v27, v41, v41
  v_dot2c_f32_bf16 v24, v42, v23
  v_dot2c_f32_bf16 v26, v42, v42
  v_dot2c_f32_bf16 v25, v43, v23
  v_dot2c_f32_bf16 v27, v43, v43
  s_waitcnt vmcnt(20)
  v_dot2c_f32_bf16 v24, v44, v23
  v_dot2c_f32_bf16 v26, v44, v44
  v_dot2c_f32_bf16 v25, v45, v23
  v_dot2c_f32_bf16 v27, v45, v45
  v_dot2c_f32_bf16 v24, v46, v23
  v_dot2c_f32_bf16 v26, v46, v46
  v_dot2c_f32_bf16 v25, v47, v23
  v_dot2c_f32_bf16 v27, v47, v47
  s_waitcnt vmcnt(19)
  v_dot2c_f32_bf16 v24, v48, v23
  v_dot2c_f32_bf16 v26, v48, v48
  v_dot2c_f32_bf16 v25, v49, v23
  v_dot2c_f32_bf16 v27, v49, v49
  v_dot2c_f32_bf16 v24, v50, v23
  v_dot2c_f32_bf16 v26, v50, v50
  v_dot2c_f32_bf16 v25, v51, v23
  v_dot2c_f32_bf16 v27, v51, v51
  s_waitcnt vmcnt(18)
  v_dot2c_f32_bf16 v24, v52, v23
  v_dot2c_f32_bf16 v26, v52, v52
  v_dot2c_f32_bf16 v25, v53, v23
  v_dot2c_f32_bf16 v27, v53, v53
  v_dot2c_f32_bf16 v24, v54, v23
  v_dot2c_f32_bf16 v26, v54, v54
  v_dot2c_f32_bf16 v25, v55, v23
  v_dot2c_f32_bf16 v27, v55, v55
  s_waitcnt vmcnt(17)
  v_dot2c_f32_bf16 v24, v56, v23
  v_dot2c_f32_bf16 v26, v56, v56
  v_dot2c_f32_bf16 v25, v57, v23
  v_dot2c_f32_bf16 v27, v57, v57
  v_dot2c_f32_bf16 v24, v58, v23
  v_dot2c_f32_bf16 v26, v58, v58
  v_dot2c_f32_bf16 v25, v59, v23
  v_dot2c_f32_bf16 v27, v59, v59
  s_waitcnt vmcnt(16)
  v_dot2c_f32_bf16 v24, v60, v23
  v_dot2c_f32_bf16 v26, v60, v60
  v_dot2c_f32_bf16 v25, v61, v23
  v_dot2c_f32_bf16 v27, v61, v61
  v_dot2c_f32_bf16 v24, v62, v23
  v_dot2c_f32_bf16 v26, v62, v62
  v_dot2c_f32_bf16 v25, v63, v23
  v_dot2c_f32_bf16 v27, v63, v63
  s_branch L_xw_d
L_xw_c:
  s_waitcnt vmcnt(7)
  v_dot2c_f32_bf16 v24, v32, v23
  v_dot2c_f32_bf16 v26, v32, v32
  v_dot2c_f32_bf16 v25, v33, v23
  v_dot2c_f32_bf16 v27, v33, v33
  v_dot2c_f32_bf16 v24, v34, v23
  v_dot2c_f32_bf16 v26, v34, v34
  v_dot2c_f32_bf16 v25, v35, v23
  v_dot2c_f32_bf16 v27, v35, v35
  s_waitcnt vmcnt(6)
  v_dot2c_f32_bf16 v24, v36, v23
  v_dot2c_f32_bf16 v26, v36, v36
  v_dot2c_f32_bf16 v25, v37, v23
  v_dot2c_f32_bf16 v27, v37, v37
  v_dot2c_f32_bf16 v24, v38, v23
  v_dot2c_f32_bf16 v26, v38, v38
  v_dot2c_f32_bf16 v25, v39, v23
  v_dot2c_f32_bf16 v27, v39, v39
  s_waitcnt vmcnt(5)
  v_dot2c_f32_bf16 v24, v40, v23
  v_dot2c_f32_bf16 v26, v40, v40
  v_dot2c_f32_bf16 v25, v41, v23
  v_dot2c_f32_bf16 v27, v41, v41
  v_dot2c_f32_bf16 v24, v42, v23
  v_dot2c_f32_bf16 v26, v42, v42
  v_dot2c_f32_bf16 v25, v43, v23
  v_dot2c_f32_bf16 v27, v43, v43
  s_waitcnt vmcnt(4)
  v_dot2c_f32_bf16 v24, v44, v23
  v_dot2c_f32_bf16 v26, v44, v44
  v_dot2c_f32_bf16 v25, v45, v23
  v_dot2c_f32_bf16 v27, v45, v45
  v_dot2c_f32_bf16 v24, v46, v23
  v_dot2c_f32_bf16 v26, v46, v46
  v_dot2c_f32_bf16 v25, v47, v23
  v_dot2c_f32_bf16 v27, v47, v47
  s_waitcnt vmcnt(3)
  v_dot2c_f32_bf16 v24, v48, v23
  v_dot2c_f32_bf16 v26, v48, v48
  v_dot2c_f32_bf16 v25, v49, v23
  v_dot2c_f32_bf16 v27, v49, v49
  v_dot2c_f32_bf16 v24, v50, v23
  v_dot2c_f32_bf16 v26, v50, v50
  v_dot2c_f32_bf16 v25, v51, v23
  v_dot2c_f32_bf16 v27, v51, v51
  s_waitcnt vmcnt(2)
  v_dot2c_f32_bf16 v24, v52, v23
  v_dot2c_f32_bf16 v26, v52, v52
  v_dot2c_f32_bf16 v25, v53, v23
  v_dot2c_f32_bf16 v27, v53, v53
  v_dot2c_f32_bf16 v24, v54, v23
  v_dot2c_f32_bf16 v26, v54, v54
  v_dot2c_f32_bf16 v25, v55, v23
  v_dot2c_f32_bf16 v27, v55, v55
  s_waitcnt vmcnt(1)
  v_dot2c_f32_bf16 v24, v56, v23
  v_dot2c_f32_bf16 v26, v56, v56
  v_dot2c_f32_bf16 v25, v57, v23
  v_dot2c_f32_bf16 v27, v57, v57
  v_dot2c_f32_bf16 v24, v58, v23
  v_dot2c_f32_bf16 v26, v58, v58
  v_dot2c_f32_bf16 v25, v59, v23
  v_dot2c_f32_bf16 v27, v59, v59
  s_waitcnt vmcnt(0)
  v_dot2c_f32_bf16 v24, v60, v23
  v_dot2c_f32_bf16 v26, v60, v60
  v_dot2c_f32_bf16 v25, v61, v23
  v_dot2c_f32_bf16 v27, v61, v61
  v_dot2c_f32_bf16 v24, v62, v23
  v_dot2c_f32_bf16 v26, v62, v62
  v_dot2c_f32_bf16 v25, v63, v23
  v_dot2c_f32_bf16 v27, v63, v63
L_xw_d:
  s_nop 1
  v_add_f32 v24, v24, v25
  v_add_f32 v26, v26, v27
  s_nop 0
  v_add_f32_dpp v25, v24, v24 quad_perm:[1,0,3,2] row_mask:0xf bank_mask:0xf
  v_add_f32_dpp v27, v26, v26 quad_perm:[1,0,3,2] row_mask:0xf bank_mask:0xf
  v_mov_b32 v24, v25
  v_mov_b32 v26, v27
  s_nop 0
  v_add_f32_dpp v25, v24, v24 quad_perm:[2,3,0,1] row_mask:0xf bank_mask:0xf
  v_add_f32_dpp v27, v26, v26 quad_perm:[2,3,0,1] row_mask:0xf bank_mask:0xf
  v_mov_b32 v24, v25
  v_mov_b32 v26, v27
  s_nop 0
  v_add_f32_dpp v25, v24, v24 row_half_mirror row_mask:0xf bank_mask:0xf
  v_add_f32_dpp v27, v26, v26 row_half_mirror row_mask:0xf bank_mask:0xf
  v_mov_b32 v24, v25
  v_mov_b32 v26, v27
  v_mul_f32 v6, 0x3b000000, v24
  v_mul_f32 v7, 0x3b000000, v26
  v_fma_f32 v7, -v6, v6, v7
  v_max_f32 v7, 0, v7
  v_add_f32 v7, 0x3727c5ac, v7
  v_rsq_f32 v30, v7
  s_nop 0
  v_mul_f32 v31, v6, v30
  v_sub_f32 v31, 0, v31
  v_lshlrev_b32 v64, 16, v32
  v_and_b32 v65, 0xffff0000, v32
  v_pk_fma_f32 v[64:65], v[64:65], v[30:31], v[30:31] op_sel:[0,0,1] op_sel_hi:[1,0,1]
  v_cvt_pk_bf16_f32 v32, v64, v65
  v_lshlrev_b32 v66, 16, v33
  v_and_b32 v67, 0xffff0000, v33
  v_pk_fma_f32 v[66:67], v[66:67], v[30:31], v[30:31] op_sel:[0,0,1] op_sel_hi:[1,0,1]
  v_cvt_pk_bf16_f32 v33, v66, v67
  v_lshlrev_b32 v68, 16, v34
  v_and_b32 v69, 0xffff0000, v34
  v_pk_fma_f32 v[68:69], v[68:69], v[30:31], v[30:31] op_sel:[0,0,1] op_sel_hi:[1,0,1]
  v_cvt_pk_bf16_f32 v34, v68, v69
  v_lshlrev_b32 v70, 16, v35
  v_and_b32 v71, 0xffff0000, v35
  v_pk_fma_f32 v[70:71], v[70:71], v[30:31], v[30:31] op_sel:[0,0,1] op_sel_hi:[1,0,1]
  v_cvt_pk_bf16_f32 v35, v70, v71
  ds_write_b128 v28, v[32:35] offset:0
  v_lshlrev_b32 v72, 16, v36
  v_and_b32 v73, 0xffff0000, v36
  v_pk_fma_f32 v[72:73], v[72:73], v[30:31], v[30:31] op_sel:[0,0,1] op_sel_hi:[1,0,1]
  v_cvt_pk_bf16_f32 v36, v72, v73
  v_lshlrev_b32 v74, 16, v37
  v_and_b32 v75, 0xffff0000, v37
  v_pk_fma_f32 v[74:75], v[74:75], v[30:31], v[30:31] op_sel:[0,0,1] op_sel_hi:[1,0,1]
  v_cvt_pk_bf16_f32 v37, v74, v75
  v_lshlrev_b32 v76, 16, v38
  v_and_b32 v77, 0xffff0000, v38
  v_pk_fma_f32 v[76:77], v[76:77], v[30:31], v[30:31] op_sel:[0,0,1] op_sel_hi:[1,0,1]
  v_cvt_pk_bf16_f32 v38, v76, v77
  v_lshlrev_b32 v78, 16, v39
  v_and_b32 v79, 0xffff0000, v39
  v_pk_fma_f32 v[78:79], v[78:79], v[30:31], v[30:31] op_sel:[0,0,1] op_sel_hi:[1,0,1]
  v_cvt_pk_bf16_f32 v39, v78, v79
  ds_write_b128 v28, v[36:39] offset:8192
  v_lshlrev_b32 v64, 16, v40
  v_and_b32 v65, 0xffff0000, v40
  v_pk_fma_f32 v[64:65], v[64:65], v[30:31], v[30:31] op_sel:[0,0,1] op_sel_hi:[1,0,1]
  v_cvt_pk_bf16_f32 v40, v64, v65
  v_lshlrev_b32 v66, 16, v41
  v_and_b32 v67, 0xffff0000, v41
  v_pk_fma_f32 v[66:67], v[66:67], v[30:31], v[30:31] op_sel:[0,0,1] op_sel_hi:[1,0,1]
  v_cvt_pk_bf16_f32 v41, v66, v67
  v_lshlrev_b32 v68, 16, v42
  v_and_b32 v69, 0xffff0000, v42
  v_pk_fma_f32 v[68:69], v[68:69], v[30:31], v[30:31] op_sel:[0,0,1] op_sel_hi:[1,0,1]
  v_cvt_pk_bf16_f32 v42, v68, v69
  v_lshlrev_b32 v70, 16, v43
  v_and_b32 v71, 0xffff0000, v43
  v_pk_fma_f32 v[70:71], v[70:71], v[30:31], v[30:31] op_sel:[0,0,1] op_sel_hi:[1,0,1]
  v_cvt_pk_bf16_f32 v43, v70, v71
  ds_write_b128 v28, v[40:43] offset:16384
  v_lshlrev_b32 v72, 16, v44
  v_and_b32 v73, 0xffff0000, v44
  v_pk_fma_f32 v[72:73], v[72:73], v[30:31], v[30:31] op_sel:[0,0,1] op_sel_hi:[1,0,1]
  v_cvt_pk_bf16_f32 v44, v72, v73
  v_lshlrev_b32 v74, 16, v45
  v_and_b32 v75, 0xffff0000, v45
  v_pk_fma_f32 v[74:75], v[74:75], v[30:31], v[30:31] op_sel:[0,0,1] op_sel_hi:[1,0,1]
  v_cvt_pk_bf16_f32 v45, v74, v75
  v_lshlrev_b32 v76, 16, v46
  v_and_b32 v77, 0xffff0000, v46
  v_pk_fma_f32 v[76:77], v[76:77], v[30:31], v[30:31] op_sel:[0,0,1] op_sel_hi:[1,0,1]
  v_cvt_pk_bf16_f32 v46, v76, v77
  v_lshlrev_b32 v78, 16, v47
  v_and_b32 v79, 0xffff0000, v47
  v_pk_fma_f32 v[78:79], v[78:79], v[30:31], v[30:31] op_sel:[0,0,1] op_sel_hi:[1,0,1]
  v_cvt_pk_bf16_f32 v47, v78, v79
  ds_write_b128 v28, v[44:47] offset:24576
  v_lshlrev_b32 v64, 16, v48
  v_and_b32 v65, 0xffff0000, v48
  v_pk_fma_f32 v[64:65], v[64:65], v[30:31], v[30:31] op_sel:[0,0,1] op_sel_hi:[1,0,1]
  v_cvt_pk_bf16_f32 v48, v64, v65
  v_lshlrev_b32 v66, 16, v49
  v_and_b32 v67, 0xffff0000, v49
  v_pk_fma_f32 v[66:67], v[66:67], v[30:31], v[30:31] op_sel:[0,0,1] op_sel_hi:[1,0,1]
  v_cvt_pk_bf16_f32 v49, v66, v67
  v_lshlrev_b32 v68, 16, v50
  v_and_b32 v69, 0xffff0000, v50
  v_pk_fma_f32 v[68:69], v[68:69], v[30:31], v[30:31] op_sel:[0,0,1] op_sel_hi:[1,0,1]
  v_cvt_pk_bf16_f32 v50, v68, v69
  v_lshlrev_b32 v70, 16, v51
  v_and_b32 v71, 0xffff0000, v51
  v_pk_fma_f32 v[70:71], v[70:71], v[30:31], v[30:31] op_sel:[0,0,1] op_sel_hi:[1,0,1]
  v_cvt_pk_bf16_f32 v51, v70, v71
  ds_write_b128 v28, v[48:51] offset:32768
  v_lshlrev_b32 v72, 16, v52
  v_and_b32 v73, 0xffff0000, v52
  v_pk_fma_f32 v[72:73], v[72:73], v[30:31], v[30:31] op_sel:[0,0,1] op_sel_hi:[1,0,1]
  v_cvt_pk_bf16_f32 v52, v72, v73
  v_lshlrev_b32 v74, 16, v53
  v_and_b32 v75, 0xffff0000, v53
  v_pk_fma_f32 v[74:75], v[74:75], v[30:31], v[30:31] op_sel:[0,0,1] op_sel_hi:[1,0,1]
  v_cvt_pk_bf16_f32 v53, v74, v75
  v_lshlrev_b32 v76, 16, v54
  v_and_b32 v77, 0xffff0000, v54
  v_pk_fma_f32 v[76:77], v[76:77], v[30:31], v[30:31] op_sel:[0,0,1] op_sel_hi:[1,0,1]
  v_cvt_pk_bf16_f32 v54, v76, v77
  v_lshlrev_b32 v78, 16, v55
  v_and_b32 v79, 0xffff0000, v55
  v_pk_fma_f32 v[78:79], v[78:79], v[30:31], v[30:31] op_sel:[0,0,1] op_sel_hi:[1,0,1]
  v_cvt_pk_bf16_f32 v55, v78, v79
  ds_write_b128 v28, v[52:55] offset:40960
  v_lshlrev_b32 v64, 16, v56
  v_and_b32 v65, 0xffff0000, v56
  v_pk_fma_f32 v[64:65], v[64:65], v[30:31], v[30:31] op_sel:[0,0,1] op_sel_hi:[1,0,1]
  v_cvt_pk_bf16_f32 v56, v64, v65
  v_lshlrev_b32 v66, 16, v57
  v_and_b32 v67, 0xffff0000, v57
  v_pk_fma_f32 v[66:67], v[66:67], v[30:31], v[30:31] op_sel:[0,0,1] op_sel_hi:[1,0,1]
  v_cvt_pk_bf16_f32 v57, v66, v67
  v_lshlrev_b32 v68, 16, v58
  v_and_b32 v69, 0xffff0000, v58
  v_pk_fma_f32 v[68:69], v[68:69], v[30:31], v[30:31] op_sel:[0,0,1] op_sel_hi:[1,0,1]
  v_cvt_pk_bf16_f32 v58, v68, v69
  v_lshlrev_b32 v70, 16, v59
  v_and_b32 v71, 0xffff0000, v59
  v_pk_fma_f32 v[70:71], v[70:71], v[30:31], v[30:31] op_sel:[0,0,1] op_sel_hi:[1,0,1]
  v_cvt_pk_bf16_f32 v59, v70, v71
  ds_write_b128 v28, v[56:59] offset:49152
  v_lshlrev_b32 v72, 16, v60
  v_and_b32 v73, 0xffff0000, v60
  v_pk_fma_f32 v[72:73], v[72:73], v[30:31], v[30:31] op_sel:[0,0,1] op_sel_hi:[1,0,1]
  v_cvt_pk_bf16_f32 v60, v72, v73
  v_lshlrev_b32 v74, 16, v61
  v_and_b32 v75, 0xffff0000, v61
  v_pk_fma_f32 v[74:75], v[74:75], v[30:31], v[30:31] op_sel:[0,0,1] op_sel_hi:[1,0,1]
  v_cvt_pk_bf16_f32 v61, v74, v75
  v_lshlrev_b32 v76, 16, v62
  v_and_b32 v77, 0xffff0000, v62
  v_pk_fma_f32 v[76:77], v[76:77], v[30:31], v[30:31] op_sel:[0,0,1] op_sel_hi:[1,0,1]
  v_cvt_pk_bf16_f32 v62, v76, v77
  v_lshlrev_b32 v78, 16, v63
  v_and_b32 v79, 0xffff0000, v63
  v_pk_fma_f32 v[78:79], v[78:79], v[30:31], v[30:31] op_sel:[0,0,1] op_sel_hi:[1,0,1]
  v_cvt_pk_bf16_f32 v63, v78, v79
  ds_write_b128 v28, v[60:63] offset:57344
  s_cmp_ge_u32 s46, 4
  s_cbranch_scc1 L_helper
  s_cmp_eq_u32 s46, 3
  s_cbranch_scc1 L_c3
  v_bfe_u32 v5, v4, 1, 3
  v_lshlrev_b32 v6, 7, v4
  v_add_u32 v8, 0, v3
  v_xor_b32 v8, v8, v5
  v_lshl_add_u32 v10, v8, 4, v6
  v_add_u32 v8, 2, v3
  v_xor_b32 v8, v8, v5
  v_lshl_add_u32 v11, v8, 4, v6
  v_add_u32 v8, 4, v3
  v_xor_b32 v8, v8, v5
  v_lshl_add_u32 v12, v8, 4, v6
  v_add_u32 v8, 6, v3
  v_xor_b32 v8, v8, v5
  v_lshl_add_u32 v13, v8, 4, v6
  v_bfe_u32 v7, v1, 2, 2
  v_lshl_add_u32 v7, v3, 3, v7
  v_mul_u32_u24 v7, 192, v7
  v_bfe_u32 v8, v1, 4, 1
  v_lshlrev_b32 v8, 5, v8
  v_and_b32 v9, 1, v1
  v_lshl_add_u32 v8, v9, 4, v8
  v_bfe_u32 v9, v1, 1, 1
  v_lshl_add_u32 v8, v9, 3, v8
  v_add_u32 v7, v7, v8
  s_lshl_b32 s3, s46, 6
  s_add_u32 s3, s3, 65536
  v_add_u32 v14, s3, v7
  v_add_u32 v15, 16384, v14
  v_lshlrev_b32 v5, 3, v3
  v_sub_u32 v5, v4, v5
  v_and_b32 v6, 1, v5
  v_lshlrev_b32 v6, 4, v6
  v_mov_b32 v7, 0x3f80
  v_lshlrev_b32 v6, v6, v7
  v_lshrrev_b32 v5, 1, v5
  v_cmp_eq_u32 vcc, 0, v5
  s_nop 1
  v_cndmask_b32 v7, 0, v6, vcc
  v_accvgpr_write_b32 a0, v7
  v_cmp_eq_u32 vcc, 1, v5
  s_nop 1
  v_cndmask_b32 v7, 0, v6, vcc
  v_accvgpr_write_b32 a1, v7
  v_cmp_eq_u32 vcc, 2, v5
  s_nop 1
  v_cndmask_b32 v7, 0, v6, vcc
  v_accvgpr_write_b32 a2, v7
  v_cmp_eq_u32 vcc, 3, v5
  s_nop 1
  v_cndmask_b32 v7, 0, v6, vcc
  v_accvgpr_write_b32 a3, v7
  v_lshlrev_b32 v5, 3, v3
  v_sub_u32 v5, v4, v5
  v_subrev_u32 v5, 16, v5
  v_and_b32 v6, 1, v5
  v_lshlrev_b32 v6, 4, v6
  v_mov_b32 v7, 0x3f80
  v_lshlrev_b32 v6, v6, v7
  v_lshrrev_b32 v5, 1, v5
  v_cmp_eq_u32 vcc, 0, v5
  s_nop 1
  v_cndmask_b32 v7, 0, v6, vcc
  v_accvgpr_write_b32 a4, v7
  v_cmp_eq_u32 vcc, 1, v5
  s_nop 1
  v_cndmask_b32 v7, 0, v6, vcc
  v_accvgpr_write_b32 a5, v7
  v_cmp_eq_u32 vcc, 2, v5
  s_nop 1
  v_cndmask_b32 v7, 0, v6, vcc
  v_accvgpr_write_b32 a6, v7
  v_cmp_eq_u32 vcc, 3, v5
  s_nop 1
  v_cndmask_b32 v7, 0, v6, vcc
  v_accvgpr_write_b32 a7, v7
  s_mov_b32 s51, 0
  s_mov_b32 s52, 16384
  s_mov_b32 s93, 0
  s_waitcnt lgkmcnt(0)
  s_barrier
L_pass:
  s_mov_b32 s64, 16384
  ds_read_b64_tr_b16 v[16:17], v14 offset:0
  ds_read_b64_tr_b16 v[18:19], v14 offset:768
  ds_read_b128 v[32:35], v10 offset:0
  ds_read_b128 v[36:39], v10 offset:4096
  ds_read_b64_tr_b16 v[20:21], v14 offset:3072
  ds_read_b64_tr_b16 v[22:23], v14 offset:3840
  ds_read_b128 v[40:43], v11 offset:0
  ds_read_b128 v[44:47], v11 offset:4096
  s_barrier
  s_waitcnt lgkmcnt(4)
  v_mfma_f32_32x32x16_bf16 v[64:79], v[16:19], v[32:35], 0
  ds_read_b64_tr_b16 v[24:25], v14 offset:6144
  ds_read_b64_tr_b16 v[26:27], v14 offset:6912
  v_mfma_f32_32x32x16_bf16 v[80:95], v[16:19], v[36:39], 0
  ds_read_b128 v[48:51], v12 offset:0
  ds_read_b128 v[52:55], v12 offset:4096
  s_waitcnt lgkmcnt(4)
  v_mfma_f32_32x32x16_bf16 v[64:79], v[20:23], v[40:43], v[64:79]
  ds_read_b64_tr_b16 v[28:29], v14 offset:9216
  ds_read_b64_tr_b16 v[30:31], v14 offset:9984
  v_mfma_f32_32x32x16_bf16 v[80:95], v[20:23], v[44:47], v[80:95]
  ds_read_b128 v[56:59], v13 offset:0
  ds_read_b128 v[60:63], v13 offset:4096
  s_waitcnt lgkmcnt(4)
  v_mfma_f32_32x32x16_bf16 v[64:79], v[24:27], v[48:51], v[64:79]
  ds_read_b64_tr_b16 v[16:17], v15 offset:0
  ds_read_b64_tr_b16 v[18:19], v15 offset:768
  v_mfma_f32_32x32x16_bf16 v[80:95], v[24:27], v[52:55], v[80:95]
  ds_read_b128 v[32:35], v10 offset:8192
  ds_read_b128 v[36:39], v10 offset:12288
  s_waitcnt lgkmcnt(4)
  v_mfma_f32_32x32x16_bf16 v[64:79], v[28:31], v[56:59], v[64:79]
  ds_read_b64_tr_b16 v[20:21], v15 offset:3072
  ds_read_b64_tr_b16 v[22:23], v15 offset:3840
  v_mfma_f32_32x32x16_bf16 v[80:95], v[28:31], v[60:63], v[80:95]
  ds_read_b128 v[40:43], v11 offset:8192
  ds_read_b128 v[44:47], v11 offset:12288
  v_mov_b32 v14, v15
  s_add_u32 s52, s52, 16384
  s_cmp_eq_u32 s52, 81920
  s_cselect_b32 s90, 0xffff0000, s64
  s_cselect_b32 s52, 0, s52
  v_add_u32 v15, s90, v15
  s_barrier
  s_waitcnt lgkmcnt(4)
  v_mfma_f32_32x32x16_bf16 v[64:79], v[16:19], v[32:35], v[64:79]
  ds_read_b64_tr_b16 v[24:25], v14 offset:6144
  ds_read_b64_tr_b16 v[26:27], v14 offset:6912
  v_mfma_f32_32x32x16_bf16 v[80:95], v[16:19], v[36:39], v[80:95]
  ds_read_b128 v[48:51], v12 offset:8192
  ds_read_b128 v[52:55], v12 offset:12288
  s_waitcnt lgkmcnt(4)
  v_mfma_f32_32x32x16_bf16 v[64:79], v[20:23], v[40:43], v[64:79]
  ds_read_b64_tr_b16 v[28:29], v14 offset:9216
  ds_read_b64_tr_b16 v[30:31], v14 offset:9984
  v_mfma_f32_32x32x16_bf16 v[80:95], v[20:23], v[44:47], v[80:95]
  ds_read_b128 v[56:59], v13 offset:8192
  ds_read_b128 v[60:63], v13 offset:12288
  s_waitcnt lgkmcnt(4)
  v_mfma_f32_32x32x16_bf16 v[64:79], v[24:27], v[48:51], v[64:79]
  ds_read_b64_tr_b16 v[16:17], v15 offset:0
  ds_read_b64_tr_b16 v[18:19], v15 offset:768
  v_mfma_f32_32x32x16_bf16 v[80:95], v[24:27], v[52:55], v[80:95]
  ds_read_b128 v[32:35], v10 offset:16384
  ds_read_b128 v[36:39], v10 offset:20480
  s_waitcnt lgkmcnt(4)
  v_mfma_f32_32x32x16_bf16 v[64:79], v[28:31], v[56:59], v[64:79]
  ds_read_b64_tr_b16 v[20:21], v15 offset:3072
  ds_read_b64_tr_b16 v[22:23], v15 offset:3840
  v_mfma_f32_32x32x16_bf16 v[80:95], v[28:31], v[60:63], v[80:95]
  ds_read_b128 v[40:43], v11 offset:16384
  ds_read_b128 v[44:47], v11 offset:20480
  v_mov_b32 v14, v15
  s_add_u32 s52, s52, 16384
  s_cmp_eq_u32 s52, 81920
  s_cselect_b32 s90, 0xffff0000, s64
  s_cselect_b32 s52, 0, s52
  v_add_u32 v15, s90, v15
  s_barrier
  s_waitcnt lgkmcnt(4)
  v_mfma_f32_32x32x16_bf16 v[64:79], v[16:19], v[32:35], v[64:79]
  ds_read_b64_tr_b16 v[24:25], v14 offset:6144
  ds_read_b64_tr_b16 v[26:27], v14 offset:6912
  v_mfma_f32_32x32x16_bf16 v[80:95], v[16:19], v[36:39], v[80:95]
  ds_read_b128 v[48:51], v12 offset:16384
  ds_read_b128 v[52:55], v12 offset:20480
  s_waitcnt lgkmcnt(4)
  v_mfma_f32_32x32x16_bf16 v[64:79], v[20:23], v[40:43], v[64:79]
  ds_read_b64_tr_b16 v[28:29], v14 offset:9216
  ds_read_b64_tr_b16 v[30:31], v14 offset:9984
  v_mfma_f32_32x32x16_bf16 v[80:95], v[20:23], v[44:47], v[80:95]
  ds_read_b128 v[56:59], v13 offset:16384
  ds_read_b128 v[60:63], v13 offset:20480
  s_waitcnt lgkmcnt(4)
  v_mfma_f32_32x32x16_bf16 v[64:79], v[24:27], v[48:51], v[64:79]
  ds_read_b64_tr_b16 v[16:17], v15 offset:0
  ds_read_b64_tr_b16 v[18:19], v15 offset:768
  v_mfma_f32_32x32x16_bf16 v[80:95], v[24:27], v[52:55], v[80:95]
  ds_read_b128 v[32:35], v10 offset:24576
  ds_read_b128 v[36:39], v10 offset:28672
  s_waitcnt lgkmcnt(4)
  v_mfma_f32_32x32x16_bf16 v[64:79], v[28:31], v[56:59], v[64:79]
  ds_read_b64_tr_b16 v[20:21], v15 offset:3072
  ds_read_b64_tr_b16 v[22:23], v15 offset:3840
  v_mfma_f32_32x32x16_bf16 v[80:95], v[28:31], v[60:63], v[80:95]
  ds_read_b128 v[40:43], v11 offset:24576
  ds_read_b128 v[44:47], v11 offset:28672
  v_mov_b32 v14, v15
  s_add_u32 s52, s52, 16384
  s_cmp_eq_u32 s52, 81920
  s_cselect_b32 s90, 0xffff0000, s64
  s_cselect_b32 s52, 0, s52
  v_add_u32 v15, s90, v15
  s_barrier
  s_waitcnt lgkmcnt(4)
  v_mfma_f32_32x32x16_bf16 v[64:79], v[16:19], v[32:35], v[64:79]
  ds_read_b64_tr_b16 v[24:25], v14 offset:6144
  ds_read_b64_tr_b16 v[26:27], v14 offset:6912
  v_mfma_f32_32x32x16_bf16 v[80:95], v[16:19], v[36:39], v[80:95]
  ds_read_b128 v[48:51], v12 offset:24576
  ds_read_b128 v[52:55], v12 offset:28672
  s_waitcnt lgkmcnt(4)
  v_mfma_f32_32x32x16_bf16 v[64:79], v[20:23], v[40:43], v[64:79]
  ds_read_b64_tr_b16 v[28:29], v14 offset:9216
  ds_read_b64_tr_b16 v[30:31], v14 offset:9984
  v_mfma_f32_32x32x16_bf16 v[80:95], v[20:23], v[44:47], v[80:95]
  ds_read_b128 v[56:59], v13 offset:24576
  ds_read_b128 v[60:63], v13 offset:28672
  s_waitcnt lgkmcnt(4)
  v_mfma_f32_32x32x16_bf16 v[64:79], v[24:27], v[48:51], v[64:79]
  ds_read_b64_tr_b16 v[16:17], v15 offset:0
  ds_read_b64_tr_b16 v[18:19], v15 offset:768
  v_mfma_f32_32x32x16_bf16 v[80:95], v[24:27], v[52:55], v[80:95]
  ds_read_b128 v[32:35], v10 offset:32768
  ds_read_b128 v[36:39], v10 offset:36864
  s_waitcnt lgkmcnt(4)
  v_mfma_f32_32x32x16_bf16 v[64:79], v[28:31], v[56:59], v[64:79]
  ds_read_b64_tr_b16 v[20:21], v15 offset:3072
  ds_read_b64_tr_b16 v[22:23], v15 offset:3840
  v_mfma_f32_32x32x16_bf16 v[80:95], v[28:31], v[60:63], v[80:95]
  ds_read_b128 v[40:43], v11 offset:32768
  ds_read_b128 v[44:47], v11 offset:36864
  v_mov_b32 v14, v15
  s_add_u32 s52, s52, 16384
  s_cmp_eq_u32 s52, 81920
  s_cselect_b32 s90, 0xffff0000, s64
  s_cselect_b32 s52, 0, s52
  v_add_u32 v15, s90, v15
  s_barrier
  s_waitcnt lgkmcnt(4)
  v_mfma_f32_32x32x16_bf16 v[64:79], v[16:19], v[32:35], v[64:79]
  ds_read_b64_tr_b16 v[24:25], v14 offset:6144
  ds_read_b64_tr_b16 v[26:27], v14 offset:6912
  v_mfma_f32_32x32x16_bf16 v[80:95], v[16:19], v[36:39], v[80:95]
  ds_read_b128 v[48:51], v12 offset:32768
  ds_read_b128 v[52:55], v12 offset:36864
  s_waitcnt lgkmcnt(4)
  v_mfma_f32_32x32x16_bf16 v[64:79], v[20:23], v[40:43], v[64:79]
  ds_read_b64_tr_b16 v[28:29], v14 offset:9216
  ds_read_b64_tr_b16 v[30:31], v14 offset:9984
  v_mfma_f32_32x32x16_bf16 v[80:95], v[20:23], v[44:47], v[80:95]
  ds_read_b128 v[56:59], v13 offset:32768
  ds_read_b128 v[60:63], v13 offset:36864
  s_waitcnt lgkmcnt(4)
  v_mfma_f32_32x32x16_bf16 v[64:79], v[24:27], v[48:51], v[64:79]
  ds_read_b64_tr_b16 v[16:17], v15 offset:0
  ds_read_b64_tr_b16 v[18:19], v15 offset:768
  v_mfma_f32_32x32x16_bf16 v[80:95], v[24:27], v[52:55], v[80:95]
  ds_read_b128 v[32:35], v10 offset:40960
  ds_read_b128 v[36:39], v10 offset:45056
  s_waitcnt lgkmcnt(4)
  v_mfma_f32_32x32x16_bf16 v[64:79], v[28:31], v[56:59], v[64:79]
  ds_read_b64_tr_b16 v[20:21], v15 offset:3072
  ds_read_b64_tr_b16 v[22:23], v15 offset:3840
  v_mfma_f32_32x32x16_bf16 v[80:95], v[28:31], v[60:63], v[80:95]
  ds_read_b128 v[40:43], v11 offset:40960
  ds_read_b128 v[44:47], v11 offset:45056
  v_mov_b32 v14, v15
  s_add_u32 s52, s52, 16384
  s_cmp_eq_u32 s52, 81920
  s_cselect_b32 s90, 0xffff0000, s64
  s_cselect_b32 s52, 0, s52
  v_add_u32 v15, s90, v15
  s_barrier
  s_waitcnt lgkmcnt(4)
  v_mfma_f32_32x32x16_bf16 v[64:79], v[16:19], v[32:35], v[64:79]
  ds_read_b64_tr_b16 v[24:25], v14 offset:6144
  ds_read_b64_tr_b16 v[26:27], v14 offset:6912
  v_mfma_f32_32x32x16_bf16 v[80:95], v[16:19], v[36:39], v[80:95]
  ds_read_b128 v[48:51], v12 offset:40960
  ds_read_b128 v[52:55], v12 offset:45056
  s_waitcnt lgkmcnt(4)
  v_mfma_f32_32x32x16_bf16 v[64:79], v[20:23], v[40:43], v[64:79]
  ds_read_b64_tr_b16 v[28:29], v14 offset:9216
  ds_read_b64_tr_b16 v[30:31], v14 offset:9984
  v_mfma_f32_32x32x16_bf16 v[80:95], v[20:23], v[44:47], v[80:95]
  ds_read_b128 v[56:59], v13 offset:40960
  ds_read_b128 v[60:63], v13 offset:45056
  s_waitcnt lgkmcnt(4)
  v_mfma_f32_32x32x16_bf16 v[64:79], v[24:27], v[48:51], v[64:79]
  ds_read_b64_tr_b16 v[16:17], v15 offset:0
  ds_read_b64_tr_b16 v[18:19], v15 offset:768
  v_mfma_f32_32x32x16_bf16 v[80:95], v[24:27], v[52:55], v[80:95]
  ds_read_b128 v[32:35], v10 offset:49152
  ds_read_b128 v[36:39], v10 offset:53248
  s_waitcnt lgkmcnt(4)
  v_mfma_f32_32x32x16_bf16 v[64:79], v[28:31], v[56:59], v[64:79]
  ds_read_b64_tr_b16 v[20:21], v15 offset:3072
  ds_read_b64_tr_b16 v[22:23], v15 offset:3840
  v_mfma_f32_32x32x16_bf16 v[80:95], v[28:31], v[60:63], v[80:95]
  ds_read_b128 v[40:43], v11 offset:49152
  ds_read_b128 v[44:47], v11 offset:53248
  v_mov_b32 v14, v15
  s_add_u32 s52, s52, 16384
  s_cmp_eq_u32 s52, 81920
  s_cselect_b32 s90, 0xffff0000, s64
  s_cselect_b32 s52, 0, s52
  v_add_u32 v15, s90, v15
  s_barrier
  s_waitcnt lgkmcnt(4)
  v_mfma_f32_32x32x16_bf16 v[64:79], v[16:19], v[32:35], v[64:79]
  ds_read_b64_tr_b16 v[24:25], v14 offset:6144
  ds_read_b64_tr_b16 v[26:27], v14 offset:6912
  v_mfma_f32_32x32x16_bf16 v[80:95], v[16:19], v[36:39], v[80:95]
  ds_read_b128 v[48:51], v12 offset:49152
  ds_read_b128 v[52:55], v12 offset:53248
  s_waitcnt lgkmcnt(4)
  v_mfma_f32_32x32x16_bf16 v[64:79], v[20:23], v[40:43], v[64:79]
  ds_read_b64_tr_b16 v[28:29], v14 offset:9216
  ds_read_b64_tr_b16 v[30:31], v14 offset:9984
  v_mfma_f32_32x32x16_bf16 v[80:95], v[20:23], v[44:47], v[80:95]
  ds_read_b128 v[56:59], v13 offset:49152
  ds_read_b128 v[60:63], v13 offset:53248
  s_waitcnt lgkmcnt(4)
  v_mfma_f32_32x32x16_bf16 v[64:79], v[24:27], v[48:51], v[64:79]
  ds_read_b64_tr_b16 v[16:17], v15 offset:0
  ds_read_b64_tr_b16 v[18:19], v15 offset:768
  v_mfma_f32_32x32x16_bf16 v[80:95], v[24:27], v[52:55], v[80:95]
  ds_read_b128 v[32:35], v10 offset:57344
  ds_read_b128 v[36:39], v10 offset:61440
  s_waitcnt lgkmcnt(4)
  v_mfma_f32_32x32x16_bf16 v[64:79], v[28:31], v[56:59], v[64:79]
  ds_read_b64_tr_b16 v[20:21], v15 offset:3072
  ds_read_b64_tr_b16 v[22:23], v15 offset:3840
  v_mfma_f32_32x32x16_bf16 v[80:95], v[28:31], v[60:63], v[80:95]
  ds_read_b128 v[40:43], v11 offset:57344
  ds_read_b128 v[44:47], v11 offset:61440
  v_mov_b32 v14, v15
  s_add_u32 s52, s52, 16384
  s_cmp_eq_u32 s52, 81920
  s_cselect_b32 s90, 0xffff0000, s64
  s_cselect_b32 s52, 0, s52
  v_add_u32 v15, s90, v15
  s_barrier
  s_waitcnt lgkmcnt(4)
  v_mfma_f32_32x32x16_bf16 v[64:79], v[16:19], v[32:35], v[64:79]
  ds_read_b64_tr_b16 v[24:25], v14 offset:6144
  ds_read_b64_tr_b16 v[26:27], v14 offset:6912
  v_mfma_f32_32x32x16_bf16 v[80:95], v[16:19], v[36:39], v[80:95]
  ds_read_b128 v[48:51], v12 offset:57344
  ds_read_b128 v[52:55], v12 offset:61440
  s_waitcnt lgkmcnt(4)
  v_mfma_f32_32x32x16_bf16 v[64:79], v[20:23], v[40:43], v[64:79]
  ds_read_b64_tr_b16 v[28:29], v14 offset:9216
  ds_read_b64_tr_b16 v[30:31], v14 offset:9984
  v_mfma_f32_32x32x16_bf16 v[80:95], v[20:23], v[44:47], v[80:95]
  ds_read_b128 v[56:59], v13 offset:57344
  ds_read_b128 v[60:63], v13 offset:61440
  s_waitcnt lgkmcnt(4)
  v_mfma_f32_32x32x16_bf16 v[64:79], v[24:27], v[48:51], v[64:79]
  ds_read_b64_tr_b16 v[16:17], v15 offset:0
  ds_read_b64_tr_b16 v[18:19], v15 offset:768
  v_mfma_f32_32x32x16_bf16 v[80:95], v[24:27], v[52:55], v[80:95]
  ds_read_b128 v[32:35], v10 offset:0
  ds_read_b128 v[36:39], v10 offset:4096
  s_waitcnt lgkmcnt(4)
  v_mfma_f32_32x32x16_bf16 v[64:79], v[28:31], v[56:59], v[64:79]
  ds_read_b64_tr_b16 v[20:21], v15 offset:3072
  ds_read_b64_tr_b16 v[22:23], v15 offset:3840
  v_mfma_f32_32x32x16_bf16 v[80:95], v[28:31], v[60:63], v[80:95]
  ds_read_b128 v[40:43], v11 offset:0
  ds_read_b128 v[44:47], v11 offset:4096
  v_mov_b32 v14, v15
  s_add_u32 s52, s52, 16384
  s_cmp_eq_u32 s52, 81920
  s_cselect_b32 s90, 0xffff0000, s64
  s_cselect_b32 s52, 0, s52
  v_add_u32 v15, s90, v15
  s_waitcnt lgkmcnt(0)
  s_cmp_lg_u32 s93, 0
  s_cbranch_scc1 L_passB_done
  v_mov_b32 v6, 0xc0135761
  s_mov_b32 s96, 0xbdd2d3e8
  s_mov_b32 s97, 0xbdd2d3e8
  v_pk_mul_f32 v[16:17], v[64:65], v[64:65]
  v_pk_mul_f32 v[20:21], v[66:67], v[66:67]
  v_pk_fma_f32 v[16:17], v[16:17], s[96:97], v[6:7] op_sel_hi:[1,1,0]
  v_pk_fma_f32 v[20:21], v[20:21], s[96:97], v[6:7] op_sel_hi:[1,1,0]
  v_pk_mul_f32 v[16:17], v[16:17], v[64:65]
  v_pk_mul_f32 v[20:21], v[20:21], v[66:67]
  v_exp_f32 v18, v16
  v_exp_f32 v22, v20
  v_exp_f32 v19, v17
  v_exp_f32 v23, v21
  v_pk_add_f32 v[18:19], v[18:19], 1.0 op_sel_hi:[1,0]
  v_pk_add_f32 v[22:23], v[22:23], 1.0 op_sel_hi:[1,0]
  v_rcp_f32 v18, v18
  v_rcp_f32 v22, v22
  v_rcp_f32 v19, v19
  v_rcp_f32 v23, v23
  v_pk_mul_f32 v[18:19], v[64:65], v[18:19]
  v_pk_mul_f32 v[22:23], v[66:67], v[22:23]
  v_cvt_pk_bf16_f32 v96, v18, v19
  v_cvt_pk_bf16_f32 v97, v22, v23
  v_pk_mul_f32 v[16:17], v[68:69], v[68:69]
  v_pk_mul_f32 v[20:21], v[70:71], v[70:71]
  v_pk_fma_f32 v[16:17], v[16:17], s[96:97], v[6:7] op_sel_hi:[1,1,0]
  v_pk_fma_f32 v[20:21], v[20:21], s[96:97], v[6:7] op_sel_hi:[1,1,0]
  v_pk_mul_f32 v[16:17], v[16:17], v[68:69]
  v_pk_mul_f32 v[20:21], v[20:21], v[70:71]
  v_exp_f32 v18, v16
  v_exp_f32 v22, v20
  v_exp_f32 v19, v17
  v_exp_f32 v23, v21
  v_pk_add_f32 v[18:19], v[18:19], 1.0 op_sel_hi:[1,0]
  v_pk_add_f32 v[22:23], v[22:23], 1.0 op_sel_hi:[1,0]
  v_rcp_f32 v18, v18
  v_rcp_f32 v22, v22
  v_rcp_f32 v19, v19
  v_rcp_f32 v23, v23
  v_pk_mul_f32 v[18:19], v[68:69], v[18:19]
  v_pk_mul_f32 v[22:23], v[70:71], v[22:23]
  v_cvt_pk_bf16_f32 v98, v18, v19
  v_cvt_pk_bf16_f32 v99, v22, v23
  v_pk_mul_f32 v[16:17], v[72:73], v[72:73]
  v_pk_mul_f32 v[20:21], v[74:75], v[74:75]
  v_pk_fma_f32 v[16:17], v[16:17], s[96:97], v[6:7] op_sel_hi:[1,1,0]
  v_pk_fma_f32 v[20:21], v[20:21], s[96:97], v[6:7] op_sel_hi:[1,1,0]
  v_pk_mul_f32 v[16:17], v[16:17], v[72:73]
  v_pk_mul_f32 v[20:21], v[20:21], v[74:75]
  v_exp_f32 v18, v16
  v_exp_f32 v22, v20
  v_exp_f32 v19, v17
  v_exp_f32 v23, v21
  v_pk_add_f32 v[18:19], v[18:19], 1.0 op_sel_hi:[1,0]
  v_pk_add_f32 v[22:23], v[22:23], 1.0 op_sel_hi:[1,0]
  v_rcp_f32 v18, v18
  v_rcp_f32 v22, v22
  v_rcp_f32 v19, v19
  v_rcp_f32 v23, v23
  v_pk_mul_f32 v[18:19], v[72:73], v[18:19]
  v_pk_mul_f32 v[22:23], v[74:75], v[22:23]
  v_cvt_pk_bf16_f32 v100, v18, v19
  v_cvt_pk_bf16_f32 v101, v22, v23
  v_pk_mul_f32 v[16:17], v[76:77], v[76:77]
  v_pk_mul_f32 v[20:21], v[78:79], v[78:79]
  v_pk_fma_f32 v[16:17], v[16:17], s[96:97], v[6:7] op_sel_hi:[1,1,0]
  v_pk_fma_f32 v[20:21], v[20:21], s[96:97], v[6:7] op_sel_hi:[1,1,0]
  v_pk_mul_f32 v[16:17], v[16:17], v[76:77]
  v_pk_mul_f32 v[20:21], v[20:21], v[78:79]
  v_exp_f32 v18, v16
  v_exp_f32 v22, v20
  v_exp_f32 v19, v17
  v_exp_f32 v23, v21
  v_pk_add_f32 v[18:19], v[18:19], 1.0 op_sel_hi:[1,0]
  v_pk_add_f32 v[22:23], v[22:23], 1.0 op_sel_hi:[1,0]
  v_rcp_f32 v18, v18
  v_rcp_f32 v22, v22
  v_rcp_f32 v19, v19
  v_rcp_f32 v23, v23
  v_pk_mul_f32 v[18:19], v[76:77], v[18:19]
  v_pk_mul_f32 v[22:23], v[78:79], v[22:23]
  v_cvt_pk_bf16_f32 v102, v18, v19
  v_cvt_pk_bf16_f32 v103, v22, v23
  v_pk_mul_f32 v[16:17], v[80:81], v[80:81]
  v_pk_mul_f32 v[20:21], v[82:83], v[82:83]
  v_pk_fma_f32 v[16:17], v[16:17], s[96:97], v[6:7] op_sel_hi:[1,1,0]
  v_pk_fma_f32 v[20:21], v[20:21], s[96:97], v[6:7] op_sel_hi:[1,1,0]
  v_pk_mul_f32 v[16:17], v[16:17], v[80:81]
  v_pk_mul_f32 v[20:21], v[20:21], v[82:83]
  v_exp_f32 v18, v16
  v_exp_f32 v22, v20
  v_exp_f32 v19, v17
  v_exp_f32 v23, v21
  v_pk_add_f32 v[18:19], v[18:19], 1.0 op_sel_hi:[1,0]
  v_pk_add_f32 v[22:23], v[22:23], 1.0 op_sel_hi:[1,0]
  v_rcp_f32 v18, v18
  v_rcp_f32 v22, v22
  v_rcp_f32 v19, v19
  v_rcp_f32 v23, v23
  v_pk_mul_f32 v[18:19], v[80:81], v[18:19]
  v_pk_mul_f32 v[22:23], v[82:83], v[22:23]
  v_cvt_pk_bf16_f32 v104, v18, v19
  v_cvt_pk_bf16_f32 v105, v22, v23
  v_pk_mul_f32 v[16:17], v[84:85], v[84:85]
  v_pk_mul_f32 v[20:21], v[86:87], v[86:87]
  v_pk_fma_f32 v[16:17], v[16:17], s[96:97], v[6:7] op_sel_hi:[1,1,0]
  v_pk_fma_f32 v[20:21], v[20:21], s[96:97], v[6:7] op_sel_hi:[1,1,0]
  v_pk_mul_f32 v[16:17], v[16:17], v[84:85]
  v_pk_mul_f32 v[20:21], v[20:21], v[86:87]
  v_exp_f32 v18, v16
  v_exp_f32 v22, v20
  v_exp_f32 v19, v17
  v_exp_f32 v23, v21
  v_pk_add_f32 v[18:19], v[18:19], 1.0 op_sel_hi:[1,0]
  v_pk_add_f32 v[22:23], v[22:23], 1.0 op_sel_hi:[1,0]
  v_rcp_f32 v18, v18
  v_rcp_f32 v22, v22
  v_rcp_f32 v19, v19
  v_rcp_f32 v23, v23
  v_pk_mul_f32 v[18:19], v[84:85], v[18:19]
  v_pk_mul_f32 v[22:23], v[86:87], v[22:23]
  v_cvt_pk_bf16_f32 v106, v18, v19
  v_cvt_pk_bf16_f32 v107, v22, v23
  v_pk_mul_f32 v[16:17], v[88:89], v[88:89]
  v_pk_mul_f32 v[20:21], v[90:91], v[90:91]
  v_pk_fma_f32 v[16:17], v[16:17], s[96:97], v[6:7] op_sel_hi:[1,1,0]
  v_pk_fma_f32 v[20:21], v[20:21], s[96:97], v[6:7] op_sel_hi:[1,1,0]
  v_pk_mul_f32 v[16:17], v[16:17], v[88:89]
  v_pk_mul_f32 v[20:21], v[20:21], v[90:91]
  v_exp_f32 v18, v16
  v_exp_f32 v22, v20
  v_exp_f32 v19, v17
  v_exp_f32 v23, v21
  v_pk_add_f32 v[18:19], v[18:19], 1.0 op_sel_hi:[1,0]
  v_pk_add_f32 v[22:23], v[22:23], 1.0 op_sel_hi:[1,0]
  v_rcp_f32 v18, v18
  v_rcp_f32 v22, v22
  v_rcp_f32 v19, v19
  v_rcp_f32 v23, v23
  v_pk_mul_f32 v[18:19], v[88:89], v[18:19]
  v_pk_mul_f32 v[22:23], v[90:91], v[22:23]
  v_cvt_pk_bf16_f32 v108, v18, v19
  v_cvt_pk_bf16_f32 v109, v22, v23
  v_pk_mul_f32 v[16:17], v[92:93], v[92:93]
  v_pk_mul_f32 v[20:21], v[94:95], v[94:95]
  v_pk_fma_f32 v[16:17], v[16:17], s[96:97], v[6:7] op_sel_hi:[1,1,0]
  v_pk_fma_f32 v[20:21], v[20:21], s[96:97], v[6:7] op_sel_hi:[1,1,0]
  v_pk_mul_f32 v[16:17], v[16:17], v[92:93]
  v_pk_mul_f32 v[20:21], v[20:21], v[94:95]
  v_exp_f32 v18, v16
  v_exp_f32 v22, v20
  v_exp_f32 v19, v17
  v_exp_f32 v23, v21
  v_pk_add_f32 v[18:19], v[18:19], 1.0 op_sel_hi:[1,0]
  v_pk_add_f32 v[22:23], v[22:23], 1.0 op_sel_hi:[1,0]
  v_rcp_f32 v18, v18
  v_rcp_f32 v22, v22
  v_rcp_f32 v19, v19
  v_rcp_f32 v23, v23
  v_pk_mul_f32 v[18:19], v[92:93], v[18:19]
  v_pk_mul_f32 v[22:23], v[94:95], v[22:23]
  v_cvt_pk_bf16_f32 v110, v18, v19
  v_cvt_pk_bf16_f32 v111, v22, v23
  v_mov_b32 v24, 0x3f803f80
  v_mov_b32 v16, 0
  v_mov_b32 v17, 0
  v_mov_b32 v18, 0
  v_mov_b32 v19, 0
  v_dot2c_f32_bf16 v16, v96, v24
  v_dot2c_f32_bf16 v17, v96, v96
  v_dot2c_f32_bf16 v18, v104, v24
  v_dot2c_f32_bf16 v19, v104, v104
  v_dot2c_f32_bf16 v16, v97, v24
  v_dot2c_f32_bf16 v17, v97, v97
  v_dot2c_f32_bf16 v18, v105, v24
  v_dot2c_f32_bf16 v19, v105, v105
  v_dot2c_f32_bf16 v16, v98, v24
  v_dot2c_f32_bf16 v17, v98, v98
  v_dot2c_f32_bf16 v18, v106, v24
  v_dot2c_f32_bf16 v19, v106, v106
  v_dot2c_f32_bf16 v16, v99, v24
  v_dot2c_f32_bf16 v17, v99, v99
  v_dot2c_f32_bf16 v18, v107, v24
  v_dot2c_f32_bf16 v19, v107, v107
  v_dot2c_f32_bf16 v16, v100, v24
  v_dot2c_f32_bf16 v17, v100, v100
  v_dot2c_f32_bf16 v18, v108, v24
  v_dot2c_f32_bf16 v19, v108, v108
  v_dot2c_f32_bf16 v16, v101, v24
  v_dot2c_f32_bf16 v17, v101, v101
  v_dot2c_f32_bf16 v18, v109, v24
  v_dot2c_f32_bf16 v19, v109, v109
  v_dot2c_f32_bf16 v16, v102, v24
  v_dot2c_f32_bf16 v17, v102, v102
  v_dot2c_f32_bf16 v18, v110, v24
  v_dot2c_f32_bf16 v19, v110, v110
  v_dot2c_f32_bf16 v16, v103, v24
  v_dot2c_f32_bf16 v17, v103, v103
  v_dot2c_f32_bf16 v18, v111, v24
  v_dot2c_f32_bf16 v19, v111, v111
  v_mov_b32 v20, v16
  v_mov_b32 v21, v17
  v_mov_b32 v22, v18
  v_mov_b32 v23, v19
  v_permlane32_swap_b32 v16, v20
  v_permlane32_swap_b32 v17, v21
  v_permlane32_swap_b32 v18, v22
  v_permlane32_swap_b32 v19, v23
  v_add_f32 v16, v16, v20
  v_add_f32 v17, v17, v21
  v_add_f32 v18, v18, v22
  v_add_f32 v19, v19, v23
  s_lshl_b32 s3, s46, 9
  s_add_u32 s3, s3, 147456
  v_lshlrev_b32 v8, 3, v2
  v_add_u32 v8, s3, v8
  ds_write_b64 v8, v[16:17]
  ds_write_b64 v8, v[18:19] offset:256
  s_waitcnt lgkmcnt(0)
  s_barrier
  v_mov_b32 v6, 0
  buffer_load_dword a8, v6, s[40:43], 0 offen sc1
  s_lshl_b32 s63, s44, 7
  v_lshlrev_b32 v5, 1, v4
  buffer_load_ushort a9, v5, s[36:39], s63 offen
  buffer_load_ushort a10, v5, s[36:39], s63 offen offset:64
  s_mov_b32 s93, 1
  s_branch L_pass
L_passB_done:
  s_waitcnt vmcnt(0)
  v_accvgpr_read_b32 v39, a8
  s_nop 0
  v_readfirstlane_b32 s49, v39
  s_nop 0
  s_cmp_lg_u32 s49, 0
  s_cbranch_scc1 L_hn_1
  v_mov_b32 v6, 0
  s_mov_b32 s98, 0
L_nonce_2:
  buffer_load_dword v5, v6, s[40:43], 0 offen sc1
  s_waitcnt vmcnt(0)
  v_readfirstlane_b32 s49, v5
  s_add_u32 s98, s98, 1
  s_cmp_gt_u32 s98, 0x8000
  s_cbranch_scc1 L_nonce_2_x
  s_cmp_eq_u32 s49, 0
  s_cbranch_scc1 L_nonce_2
L_nonce_2_x:
L_hn_1:
  s_barrier
  v_lshlrev_b32 v5, 3, v2
  v_add_u32 v5, 148992, v5
  ds_read_b64 v[6:7], v5
  ds_read_b64 v[8:9], v5 offset:256
  s_waitcnt lgkmcnt(0)
  v_lshlrev_b32 v16, 16, v96
  v_and_b32 v17, 0xffff0000, v96
  v_pk_fma_f32 v[16:17], v[16:17], v[6:7], v[6:7] op_sel:[0,0,1] op_sel_hi:[1,0,1]
  v_cvt_pk_bf16_f32 v48, v16, v17
  v_lshlrev_b32 v18, 16, v97
  v_and_b32 v19, 0xffff0000, v97
  v_pk_fma_f32 v[18:19], v[18:19], v[6:7], v[6:7] op_sel:[0,0,1] op_sel_hi:[1,0,1]
  v_cvt_pk_bf16_f32 v49, v18, v19
  v_lshlrev_b32 v20, 16, v98
  v_and_b32 v21, 0xffff0000, v98
  v_pk_fma_f32 v[20:21], v[20:21], v[6:7], v[6:7] op_sel:[0,0,1] op_sel_hi:[1,0,1]
  v_cvt_pk_bf16_f32 v50, v20, v21
  v_lshlrev_b32 v22, 16, v99
  v_and_b32 v23, 0xffff0000, v99
  v_pk_fma_f32 v[22:23], v[22:23], v[6:7], v[6:7] op_sel:[0,0,1] op_sel_hi:[1,0,1]
  v_cvt_pk_bf16_f32 v51, v22, v23
  v_lshlrev_b32 v16, 16, v100
  v_and_b32 v17, 0xffff0000, v100
  v_pk_fma_f32 v[16:17], v[16:17], v[6:7], v[6:7] op_sel:[0,0,1] op_sel_hi:[1,0,1]
  v_cvt_pk_bf16_f32 v52, v16, v17
  v_lshlrev_b32 v18, 16, v101
  v_and_b32 v19, 0xffff0000, v101
  v_pk_fma_f32 v[18:19], v[18:19], v[6:7], v[6:7] op_sel:[0,0,1] op_sel_hi:[1,0,1]
  v_cvt_pk_bf16_f32 v53, v18, v19
  v_lshlrev_b32 v20, 16, v102
  v_and_b32 v21, 0xffff0000, v102
  v_pk_fma_f32 v[20:21], v[20:21], v[6:7], v[6:7] op_sel:[0,0,1] op_sel_hi:[1,0,1]
  v_cvt_pk_bf16_f32 v54, v20, v21
  v_lshlrev_b32 v22, 16, v103
  v_and_b32 v23, 0xffff0000, v103
  v_pk_fma_f32 v[22:23], v[22:23], v[6:7], v[6:7] op_sel:[0,0,1] op_sel_hi:[1,0,1]
  v_cvt_pk_bf16_f32 v55, v22, v23
  v_lshlrev_b32 v16, 16, v104
  v_and_b32 v17, 0xffff0000, v104
  v_pk_fma_f32 v[16:17], v[16:17], v[8:9], v[8:9] op_sel:[0,0,1] op_sel_hi:[1,0,1]
  v_cvt_pk_bf16_f32 v56, v16, v17
  v_lshlrev_b32 v18, 16, v105
  v_and_b32 v19, 0xffff0000, v105
  v_pk_fma_f32 v[18:19], v[18:19], v[8:9], v[8:9] op_sel:[0,0,1] op_sel_hi:[1,0,1]
  v_cvt_pk_bf16_f32 v57, v18, v19
  v_lshlrev_b32 v20, 16, v106
  v_and_b32 v21, 0xffff0000, v106
  v_pk_fma_f32 v[20:21], v[20:21], v[8:9], v[8:9] op_sel:[0,0,1] op_sel_hi:[1,0,1]
  v_cvt_pk_bf16_f32 v58, v20, v21
  v_lshlrev_b32 v22, 16, v107
  v_and_b32 v23, 0xffff0000, v107
  v_pk_fma_f32 v[22:23], v[22:23], v[8:9], v[8:9] op_sel:[0,0,1] op_sel_hi:[1,0,1]
  v_cvt_pk_bf16_f32 v59, v22, v23
  v_lshlrev_b32 v16, 16, v108
  v_and_b32 v17, 0xffff0000, v108
  v_pk_fma_f32 v[16:17], v[16:17], v[8:9], v[8:9] op_sel:[0,0,1] op_sel_hi:[1,0,1]
  v_cvt_pk_bf16_f32 v60, v16, v17
  v_lshlrev_b32 v18, 16, v109
  v_and_b32 v19, 0xffff0000, v109
  v_pk_fma_f32 v[18:19], v[18:19], v[8:9], v[8:9] op_sel:[0,0,1] op_sel_hi:[1,0,1]
  v_cvt_pk_bf16_f32 v61, v18, v19
  v_lshlrev_b32 v20, 16, v110
  v_and_b32 v21, 0xffff0000, v110
  v_pk_fma_f32 v[20:21], v[20:21], v[8:9], v[8:9] op_sel:[0,0,1] op_sel_hi:[1,0,1]
  v_cvt_pk_bf16_f32 v62, v20, v21
  v_lshlrev_b32 v22, 16, v111
  v_and_b32 v23, 0xffff0000, v111
  v_pk_fma_f32 v[22:23], v[22:23], v[8:9], v[8:9] op_sel:[0,0,1] op_sel_hi:[1,0,1]
  v_cvt_pk_bf16_f32 v63, v22, v23
  v_mfma_f32_32x32x16_bf16 v[16:31], v[48:51], a[0:3], 0
  v_mfma_f32_32x32x16_bf16 v[32:47], v[56:59], a[0:3], 0
  v_mfma_f32_32x32x16_bf16 v[16:31], v[52:55], a[4:7], v[16:31]
  v_mfma_f32_32x32x16_bf16 v[32:47], v[60:63], a[4:7], v[32:47]
  s_lshl_b32 s63, s45, 7
  s_lshl_b32 s90, s44, 2
  s_add_u32 s63, s63, s90
  s_mul_i32 s63, s63, 3
  s_add_u32 s63, s63, s46
  s_lshl_b32 s63, s63, 10
  s_add_u32 s63, s63, 0x100000
  v_lshlrev_b32 v5, 4, v1
  s_nop 2
  v_cvt_pk_bf16_f32 v48, v16, v17
  v_cvt_pk_bf16_f32 v49, v18, v19
  v_cvt_pk_bf16_f32 v50, v20, v21
  v_cvt_pk_bf16_f32 v51, v22, v23
  s_add_u32 s90, s63, 0
  buffer_store_dwordx4 v[48:51], v5, s[28:31], s90 offen sc1
  v_cvt_pk_bf16_f32 v52, v24, v25
  v_cvt_pk_bf16_f32 v53, v26, v27
  v_cvt_pk_bf16_f32 v54, v28, v29
  v_cvt_pk_bf16_f32 v55, v30, v31
  s_add_u32 s90, s63, 3072
  buffer_store_dwordx4 v[52:55], v5, s[28:31], s90 offen sc1
  v_cvt_pk_bf16_f32 v56, v32, v33
  v_cvt_pk_bf16_f32 v57, v34, v35
  v_cvt_pk_bf16_f32 v58, v36, v37
  v_cvt_pk_bf16_f32 v59, v38, v39
  s_add_u32 s90, s63, 6144
  buffer_store_dwordx4 v[56:59], v5, s[28:31], s90 offen sc1
  v_cvt_pk_bf16_f32 v60, v40, v41
  v_cvt_pk_bf16_f32 v61, v42, v43
  v_cvt_pk_bf16_f32 v62, v44, v45
  v_cvt_pk_bf16_f32 v63, v46, v47
  s_add_u32 s90, s63, 9216
  buffer_store_dwordx4 v[60:63], v5, s[28:31], s90 offen sc1
  s_barrier
  v_mov_b32 v6, 0xc0135761
  s_mov_b32 s96, 0xbdd2d3e8
  s_mov_b32 s97, 0xbdd2d3e8
  v_pk_mul_f32 v[16:17], v[64:65], v[64:65]
  v_pk_mul_f32 v[20:21], v[66:67], v[66:67]
  v_pk_fma_f32 v[16:17], v[16:17], s[96:97], v[6:7] op_sel_hi:[1,1,0]
  v_pk_fma_f32 v[20:21], v[20:21], s[96:97], v[6:7] op_sel_hi:[1,1,0]
  v_pk_mul_f32 v[16:17], v[16:17], v[64:65]
  v_pk_mul_f32 v[20:21], v[20:21], v[66:67]
  v_exp_f32 v18, v16
  v_exp_f32 v22, v20
  v_exp_f32 v19, v17
  v_exp_f32 v23, v21
  v_pk_add_f32 v[18:19], v[18:19], 1.0 op_sel_hi:[1,0]
  v_pk_add_f32 v[22:23], v[22:23], 1.0 op_sel_hi:[1,0]
  v_rcp_f32 v18, v18
  v_rcp_f32 v22, v22
  v_rcp_f32 v19, v19
  v_rcp_f32 v23, v23
  v_pk_mul_f32 v[18:19], v[64:65], v[18:19]
  v_pk_mul_f32 v[22:23], v[66:67], v[22:23]
  v_cvt_pk_bf16_f32 v112, v18, v19
  v_cvt_pk_bf16_f32 v113, v22, v23
  v_pk_mul_f32 v[16:17], v[68:69], v[68:69]
  v_pk_mul_f32 v[20:21], v[70:71], v[70:71]
  v_pk_fma_f32 v[16:17], v[16:17], s[96:97], v[6:7] op_sel_hi:[1,1,0]
  v_pk_fma_f32 v[20:21], v[20:21], s[96:97], v[6:7] op_sel_hi:[1,1,0]
  v_pk_mul_f32 v[16:17], v[16:17], v[68:69]
  v_pk_mul_f32 v[20:21], v[20:21], v[70:71]
  v_exp_f32 v18, v16
  v_exp_f32 v22, v20
  v_exp_f32 v19, v17
  v_exp_f32 v23, v21
  v_pk_add_f32 v[18:19], v[18:19], 1.0 op_sel_hi:[1,0]
  v_pk_add_f32 v[22:23], v[22:23], 1.0 op_sel_hi:[1,0]
  v_rcp_f32 v18, v18
  v_rcp_f32 v22, v22
  v_rcp_f32 v19, v19
  v_rcp_f32 v23, v23
  v_pk_mul_f32 v[18:19], v[68:69], v[18:19]
  v_pk_mul_f32 v[22:23], v[70:71], v[22:23]
  v_cvt_pk_bf16_f32 v114, v18, v19
  v_cvt_pk_bf16_f32 v115, v22, v23
  v_pk_mul_f32 v[16:17], v[72:73], v[72:73]
  v_pk_mul_f32 v[20:21], v[74:75], v[74:75]
  v_pk_fma_f32 v[16:17], v[16:17], s[96:97], v[6:7] op_sel_hi:[1,1,0]
  v_pk_fma_f32 v[20:21], v[20:21], s[96:97], v[6:7] op_sel_hi:[1,1,0]
  v_pk_mul_f32 v[16:17], v[16:17], v[72:73]
  v_pk_mul_f32 v[20:21], v[20:21], v[74:75]
  v_exp_f32 v18, v16
  v_exp_f32 v22, v20
  v_exp_f32 v19, v17
  v_exp_f32 v23, v21
  v_pk_add_f32 v[18:19], v[18:19], 1.0 op_sel_hi:[1,0]
  v_pk_add_f32 v[22:23], v[22:23], 1.0 op_sel_hi:[1,0]
  v_rcp_f32 v18, v18
  v_rcp_f32 v22, v22
  v_rcp_f32 v19, v19
  v_rcp_f32 v23, v23
  v_pk_mul_f32 v[18:19], v[72:73], v[18:19]
  v_pk_mul_f32 v[22:23], v[74:75], v[22:23]
  v_cvt_pk_bf16_f32 v116, v18, v19
  v_cvt_pk_bf16_f32 v117, v22, v23
  v_pk_mul_f32 v[16:17], v[76:77], v[76:77]
  v_pk_mul_f32 v[20:21], v[78:79], v[78:79]
  v_pk_fma_f32 v[16:17], v[16:17], s[96:97], v[6:7] op_sel_hi:[1,1,0]
  v_pk_fma_f32 v[20:21], v[20:21], s[96:97], v[6:7] op_sel_hi:[1,1,0]
  v_pk_mul_f32 v[16:17], v[16:17], v[76:77]
  v_pk_mul_f32 v[20:21], v[20:21], v[78:79]
  v_exp_f32 v18, v16
  v_exp_f32 v22, v20
  v_exp_f32 v19, v17
  v_exp_f32 v23, v21
  v_pk_add_f32 v[18:19], v[18:19], 1.0 op_sel_hi:[1,0]
  v_pk_add_f32 v[22:23], v[22:23], 1.0 op_sel_hi:[1,0]
  v_rcp_f32 v18, v18
  v_rcp_f32 v22, v22
  v_rcp_f32 v19, v19
  v_rcp_f32 v23, v23
  v_pk_mul_f32 v[18:19], v[76:77], v[18:19]
  v_pk_mul_f32 v[22:23], v[78:79], v[22:23]
  v_cvt_pk_bf16_f32 v118, v18, v19
  v_cvt_pk_bf16_f32 v119, v22, v23
  s_waitcnt vmcnt(0)
  s_lshl_b32 s63, s50, 7
  s_add_u32 s63, s63, 0x8000
  s_lshl_b32 s3, s46, 2
  s_add_u32 s63, s63, s3
  v_mov_b32 v8, s49
  v_mov_b32 v9, 0
  s_mov_b64 exec, 1
  buffer_store_dword v8, v9, s[28:31], s63 offen sc1
  s_mov_b64 exec, -1
  v_pk_mul_f32 v[16:17], v[80:81], v[80:81]
  v_pk_mul_f32 v[20:21], v[82:83], v[82:83]
  v_pk_fma_f32 v[16:17], v[16:17], s[96:97], v[6:7] op_sel_hi:[1,1,0]
  v_pk_fma_f32 v[20:21], v[20:21], s[96:97], v[6:7] op_sel_hi:[1,1,0]
  v_pk_mul_f32 v[16:17], v[16:17], v[80:81]
  v_pk_mul_f32 v[20:21], v[20:21], v[82:83]
  v_exp_f32 v18, v16
  v_exp_f32 v22, v20
  v_exp_f32 v19, v17
  v_exp_f32 v23, v21
  v_pk_add_f32 v[18:19], v[18:19], 1.0 op_sel_hi:[1,0]
  v_pk_add_f32 v[22:23], v[22:23], 1.0 op_sel_hi:[1,0]
  v_rcp_f32 v18, v18
  v_rcp_f32 v22, v22
  v_rcp_f32 v19, v19
  v_rcp_f32 v23, v23
  v_pk_mul_f32 v[18:19], v[80:81], v[18:19]
  v_pk_mul_f32 v[22:23], v[82:83], v[22:23]
  v_cvt_pk_bf16_f32 v120, v18, v19
  v_cvt_pk_bf16_f32 v121, v22, v23
  v_pk_mul_f32 v[16:17], v[84:85], v[84:85]
  v_pk_mul_f32 v[20:21], v[86:87], v[86:87]
  v_pk_fma_f32 v[16:17], v[16:17], s[96:97], v[6:7] op_sel_hi:[1,1,0]
  v_pk_fma_f32 v[20:21], v[20:21], s[96:97], v[6:7] op_sel_hi:[1,1,0]
  v_pk_mul_f32 v[16:17], v[16:17], v[84:85]
  v_pk_mul_f32 v[20:21], v[20:21], v[86:87]
  v_exp_f32 v18, v16
  v_exp_f32 v22, v20
  v_exp_f32 v19, v17
  v_exp_f32 v23, v21
  v_pk_add_f32 v[18:19], v[18:19], 1.0 op_sel_hi:[1,0]
  v_pk_add_f32 v[22:23], v[22:23], 1.0 op_sel_hi:[1,0]
  v_rcp_f32 v18, v18
  v_rcp_f32 v22, v22
  v_rcp_f32 v19, v19
  v_rcp_f32 v23, v23
  v_pk_mul_f32 v[18:19], v[84:85], v[18:19]
  v_pk_mul_f32 v[22:23], v[86:87], v[22:23]
  v_cvt_pk_bf16_f32 v122, v18, v19
  v_cvt_pk_bf16_f32 v123, v22, v23
  v_pk_mul_f32 v[16:17], v[88:89], v[88:89]
  v_pk_mul_f32 v[20:21], v[90:91], v[90:91]
  v_pk_fma_f32 v[16:17], v[16:17], s[96:97], v[6:7] op_sel_hi:[1,1,0]
  v_pk_fma_f32 v[20:21], v[20:21], s[96:97], v[6:7] op_sel_hi:[1,1,0]
  v_pk_mul_f32 v[16:17], v[16:17], v[88:89]
  v_pk_mul_f32 v[20:21], v[20:21], v[90:91]
  v_exp_f32 v18, v16
  v_exp_f32 v22, v20
  v_exp_f32 v19, v17
  v_exp_f32 v23, v21
  v_pk_add_f32 v[18:19], v[18:19], 1.0 op_sel_hi:[1,0]
  v_pk_add_f32 v[22:23], v[22:23], 1.0 op_sel_hi:[1,0]
  v_rcp_f32 v18, v18
  v_rcp_f32 v22, v22
  v_rcp_f32 v19, v19
  v_rcp_f32 v23, v23
  v_pk_mul_f32 v[18:19], v[88:89], v[18:19]
  v_pk_mul_f32 v[22:23], v[90:91], v[22:23]
  v_cvt_pk_bf16_f32 v124, v18, v19
  v_cvt_pk_bf16_f32 v125, v22, v23
  v_pk_mul_f32 v[16:17], v[92:93], v[92:93]
  v_pk_mul_f32 v[20:21], v[94:95], v[94:95]
  v_pk_fma_f32 v[16:17], v[16:17], s[96:97], v[6:7] op_sel_hi:[1,1,0]
  v_pk_fma_f32 v[20:21], v[20:21], s[96:97], v[6:7] op_sel_hi:[1,1,0]
  v_pk_mul_f32 v[16:17], v[16:17], v[92:93]
  v_pk_mul_f32 v[20:21], v[20:21], v[94:95]
  v_exp_f32 v18, v16
  v_exp_f32 v22, v20
  v_exp_f32 v19, v17
  v_exp_f32 v23, v21
  v_pk_add_f32 v[18:19], v[18:19], 1.0 op_sel_hi:[1,0]
  v_pk_add_f32 v[22:23], v[22:23], 1.0 op_sel_hi:[1,0]
  v_rcp_f32 v18, v18
  v_rcp_f32 v22, v22
  v_rcp_f32 v19, v19
  v_rcp_f32 v23, v23
  v_pk_mul_f32 v[18:19], v[92:93], v[18:19]
  v_pk_mul_f32 v[22:23], v[94:95], v[22:23]
  v_cvt_pk_bf16_f32 v126, v18, v19
  v_cvt_pk_bf16_f32 v127, v22, v23
  s_branch L_c_join
L_c3:
  v_bfe_u32 v5, v4, 1, 3
  v_lshlrev_b32 v6, 7, v4
  v_add_u32 v8, 0, v3
  v_xor_b32 v8, v8, v5
  v_lshl_add_u32 v10, v8, 4, v6
  v_add_u32 v8, 2, v3
  v_xor_b32 v8, v8, v5
  v_lshl_add_u32 v11, v8, 4, v6
  v_add_u32 v8, 4, v3
  v_xor_b32 v8, v8, v5
  v_lshl_add_u32 v12, v8, 4, v6
  v_add_u32 v8, 6, v3
  v_xor_b32 v8, v8, v5
  v_lshl_add_u32 v13, v8, 4, v6
  v_add_u32 v116, 77824, v10
  v_add_u32 v117, 77824, v11
  v_add_u32 v118, 77824, v12
  v_add_u32 v119, 77824, v13
  s_mov_b32 s51, 0
  s_mov_b32 s52, 0
  s_mov_b32 s93, 0
  s_waitcnt lgkmcnt(0)
  s_barrier
L_pass3:
  s_mov_b32 s64, 16384
  v_add_u32 v120, s52, v116
  v_add_u32 v121, s52, v117
  v_add_u32 v122, s52, v118
  v_add_u32 v123, s52, v119
  ds_read_b128 v[16:19], v120
  ds_read_b128 v[32:35], v10 offset:0
  ds_read_b128 v[36:39], v10 offset:4096
  ds_read_b128 v[20:23], v121
  ds_read_b128 v[40:43], v11 offset:0
  ds_read_b128 v[44:47], v11 offset:4096
  s_barrier
  s_waitcnt lgkmcnt(3)
  v_mfma_f32_32x32x16_bf16 v[64:79], v[32:35], v[16:19], 0
  s_add_u32 s90, s52, 16384
  s_cmp_eq_u32 s90, 81920
  s_cselect_b32 s90, 0, s90
  v_add_u32 v124, s90, v116
  v_add_u32 v125, s90, v117
  ds_read_b128 v[24:27], v122
  ds_read_b128 v[48:51], v12 offset:0
  v_mfma_f32_32x32x16_bf16 v[80:95], v[36:39], v[16:19], 0
  ds_read_b128 v[52:55], v12 offset:4096
  s_waitcnt lgkmcnt(3)
  v_mfma_f32_32x32x16_bf16 v[64:79], v[40:43], v[20:23], v[64:79]
  ds_read_b128 v[28:31], v123
  ds_read_b128 v[56:59], v13 offset:0
  v_mfma_f32_32x32x16_bf16 v[80:95], v[44:47], v[20:23], v[80:95]
  ds_read_b128 v[60:63], v13 offset:4096
  s_waitcnt lgkmcnt(3)
  v_mfma_f32_32x32x16_bf16 v[64:79], v[48:51], v[24:27], v[64:79]
  ds_read_b128 v[16:19], v124
  ds_read_b128 v[32:35], v10 offset:8192
  v_mfma_f32_32x32x16_bf16 v[80:95], v[52:55], v[24:27], v[80:95]
  ds_read_b128 v[36:39], v10 offset:12288
  s_waitcnt lgkmcnt(3)
  v_mfma_f32_32x32x16_bf16 v[64:79], v[56:59], v[28:31], v[64:79]
  ds_read_b128 v[20:23], v125
  ds_read_b128 v[40:43], v11 offset:8192
  v_mfma_f32_32x32x16_bf16 v[80:95], v[60:63], v[28:31], v[80:95]
  ds_read_b128 v[44:47], v11 offset:12288
  s_mov_b32 s52, s90
  v_add_u32 v120, s52, v116
  v_add_u32 v121, s52, v117
  v_add_u32 v122, s52, v118
  v_add_u32 v123, s52, v119
  s_barrier
  s_waitcnt lgkmcnt(3)
  v_mfma_f32_32x32x16_bf16 v[64:79], v[32:35], v[16:19], v[64:79]
  s_add_u32 s90, s52, 16384
  s_cmp_eq_u32 s90, 81920
  s_cselect_b32 s90, 0, s90
  v_add_u32 v124, s90, v116
  v_add_u32 v125, s90, v117
  ds_read_b128 v[24:27], v122
  ds_read_b128 v[48:51], v12 offset:8192
  v_mfma_f32_32x32x16_bf16 v[80:95], v[36:39], v[16:19], v[80:95]
  ds_read_b128 v[52:55], v12 offset:12288
  s_waitcnt lgkmcnt(3)
  v_mfma_f32_32x32x16_bf16 v[64:79], v[40:43], v[20:23], v[64:79]
  ds_read_b128 v[28:31], v123
  ds_read_b128 v[56:59], v13 offset:8192
  v_mfma_f32_32x32x16_bf16 v[80:95], v[44:47], v[20:23], v[80:95]
  ds_read_b128 v[60:63], v13 offset:12288
  s_waitcnt lgkmcnt(3)
  v_mfma_f32_32x32x16_bf16 v[64:79], v[48:51], v[24:27], v[64:79]
  ds_read_b128 v[16:19], v124
  ds_read_b128 v[32:35], v10 offset:16384
  v_mfma_f32_32x32x16_bf16 v[80:95], v[52:55], v[24:27], v[80:95]
  ds_read_b128 v[36:39], v10 offset:20480
  s_waitcnt lgkmcnt(3)
  v_mfma_f32_32x32x16_bf16 v[64:79], v[56:59], v[28:31], v[64:79]
  ds_read_b128 v[20:23], v125
  ds_read_b128 v[40:43], v11 offset:16384
  v_mfma_f32_32x32x16_bf16 v[80:95], v[60:63], v[28:31], v[80:95]
  ds_read_b128 v[44:47], v11 offset:20480
  s_mov_b32 s52, s90
  v_add_u32 v120, s52, v116
  v_add_u32 v121, s52, v117
  v_add_u32 v122, s52, v118
  v_add_u32 v123, s52, v119
  s_barrier
  s_waitcnt lgkmcnt(3)
  v_mfma_f32_32x32x16_bf16 v[64:79], v[32:35], v[16:19], v[64:79]
  s_add_u32 s90, s52, 16384
  s_cmp_eq_u32 s90, 81920
  s_cselect_b32 s90, 0, s90
  v_add_u32 v124, s90, v116
  v_add_u32 v125, s90, v117
  ds_read_b128 v[24:27], v122
  ds_read_b128 v[48:51], v12 offset:16384
  v_mfma_f32_32x32x16_bf16 v[80:95], v[36:39], v[16:19], v[80:95]
  ds_read_b128 v[52:55], v12 offset:20480
  s_waitcnt lgkmcnt(3)
  v_mfma_f32_32x32x16_bf16 v[64:79], v[40:43], v[20:23], v[64:79]
  ds_read_b128 v[28:31], v123
  ds_read_b128 v[56:59], v13 offset:16384
  v_mfma_f32_32x32x16_bf16 v[80:95], v[44:47], v[20:23], v[80:95]
  ds_read_b128 v[60:63], v13 offset:20480
  s_waitcnt lgkmcnt(3)
  v_mfma_f32_32x32x16_bf16 v[64:79], v[48:51], v[24:27], v[64:79]
  ds_read_b128 v[16:19], v124
  ds_read_b128 v[32:35], v10 offset:24576
  v_mfma_f32_32x32x16_bf16 v[80:95], v[52:55], v[24:27], v[80:95]
  ds_read_b128 v[36:39], v10 offset:28672
  s_waitcnt lgkmcnt(3)
  v_mfma_f32_32x32x16_bf16 v[64:79], v[56:59], v[28:31], v[64:79]
  ds_read_b128 v[20:23], v125
  ds_read_b128 v[40:43], v11 offset:24576
  v_mfma_f32_32x32x16_bf16 v[80:95], v[60:63], v[28:31], v[80:95]
  ds_read_b128 v[44:47], v11 offset:28672
  s_mov_b32 s52, s90
  v_add_u32 v120, s52, v116
  v_add_u32 v121, s52, v117
  v_add_u32 v122, s52, v118
  v_add_u32 v123, s52, v119
  s_barrier
  s_waitcnt lgkmcnt(3)
  v_mfma_f32_32x32x16_bf16 v[64:79], v[32:35], v[16:19], v[64:79]
  s_add_u32 s90, s52, 16384
  s_cmp_eq_u32 s90, 81920
  s_cselect_b32 s90, 0, s90
  v_add_u32 v124, s90, v116
  v_add_u32 v125, s90, v117
  ds_read_b128 v[24:27], v122
  ds_read_b128 v[48:51], v12 offset:24576
  v_mfma_f32_32x32x16_bf16 v[80:95], v[36:39], v[16:19], v[80:95]
  ds_read_b128 v[52:55], v12 offset:28672
  s_waitcnt lgkmcnt(3)
  v_mfma_f32_32x32x16_bf16 v[64:79], v[40:43], v[20:23], v[64:79]
  ds_read_b128 v[28:31], v123
  ds_read_b128 v[56:59], v13 offset:24576
  v_mfma_f32_32x32x16_bf16 v[80:95], v[44:47], v[20:23], v[80:95]
  ds_read_b128 v[60:63], v13 offset:28672
  s_waitcnt lgkmcnt(3)
  v_mfma_f32_32x32x16_bf16 v[64:79], v[48:51], v[24:27], v[64:79]
  ds_read_b128 v[16:19], v124
  ds_read_b128 v[32:35], v10 offset:32768
  v_mfma_f32_32x32x16_bf16 v[80:95], v[52:55], v[24:27], v[80:95]
  ds_read_b128 v[36:39], v10 offset:36864
  s_waitcnt lgkmcnt(3)
  v_mfma_f32_32x32x16_bf16 v[64:79], v[56:59], v[28:31], v[64:79]
  ds_read_b128 v[20:23], v125
  ds_read_b128 v[40:43], v11 offset:32768
  v_mfma_f32_32x32x16_bf16 v[80:95], v[60:63], v[28:31], v[80:95]
  ds_read_b128 v[44:47], v11 offset:36864
  s_mov_b32 s52, s90
  v_add_u32 v120, s52, v116
  v_add_u32 v121, s52, v117
  v_add_u32 v122, s52, v118
  v_add_u32 v123, s52, v119
  s_barrier
  s_waitcnt lgkmcnt(3)
  v_mfma_f32_32x32x16_bf16 v[64:79], v[32:35], v[16:19], v[64:79]
  s_add_u32 s90, s52, 16384
  s_cmp_eq_u32 s90, 81920
  s_cselect_b32 s90, 0, s90
  v_add_u32 v124, s90, v116
  v_add_u32 v125, s90, v117
  ds_read_b128 v[24:27], v122
  ds_read_b128 v[48:51], v12 offset:32768
  v_mfma_f32_32x32x16_bf16 v[80:95], v[36:39], v[16:19], v[80:95]
  ds_read_b128 v[52:55], v12 offset:36864
  s_waitcnt lgkmcnt(3)
  v_mfma_f32_32x32x16_bf16 v[64:79], v[40:43], v[20:23], v[64:79]
  ds_read_b128 v[28:31], v123
  ds_read_b128 v[56:59], v13 offset:32768
  v_mfma_f32_32x32x16_bf16 v[80:95], v[44:47], v[20:23], v[80:95]
  ds_read_b128 v[60:63], v13 offset:36864
  s_waitcnt lgkmcnt(3)
  v_mfma_f32_32x32x16_bf16 v[64:79], v[48:51], v[24:27], v[64:79]
  ds_read_b128 v[16:19], v124
  ds_read_b128 v[32:35], v10 offset:40960
  v_mfma_f32_32x32x16_bf16 v[80:95], v[52:55], v[24:27], v[80:95]
  ds_read_b128 v[36:39], v10 offset:45056
  s_waitcnt lgkmcnt(3)
  v_mfma_f32_32x32x16_bf16 v[64:79], v[56:59], v[28:31], v[64:79]
  ds_read_b128 v[20:23], v125
  ds_read_b128 v[40:43], v11 offset:40960
  v_mfma_f32_32x32x16_bf16 v[80:95], v[60:63], v[28:31], v[80:95]
  ds_read_b128 v[44:47], v11 offset:45056
  s_mov_b32 s52, s90
  v_add_u32 v120, s52, v116
  v_add_u32 v121, s52, v117
  v_add_u32 v122, s52, v118
  v_add_u32 v123, s52, v119
  s_barrier
  s_waitcnt lgkmcnt(3)
  v_mfma_f32_32x32x16_bf16 v[64:79], v[32:35], v[16:19], v[64:79]
  s_add_u32 s90, s52, 16384
  s_cmp_eq_u32 s90, 81920
  s_cselect_b32 s90, 0, s90
  v_add_u32 v124, s90, v116
  v_add_u32 v125, s90, v117
  ds_read_b128 v[24:27], v122
  ds_read_b128 v[48:51], v12 offset:40960
  v_mfma_f32_32x32x16_bf16 v[80:95], v[36:39], v[16:19], v[80:95]
  ds_read_b128 v[52:55], v12 offset:45056
  s_waitcnt lgkmcnt(3)
  v_mfma_f32_32x32x16_bf16 v[64:79], v[40:43], v[20:23], v[64:79]
  ds_read_b128 v[28:31], v123
  ds_read_b128 v[56:59], v13 offset:40960
  v_mfma_f32_32x32x16_bf16 v[80:95], v[44:47], v[20:23], v[80:95]
  ds_read_b128 v[60:63], v13 offset:45056
  s_waitcnt lgkmcnt(3)
  v_mfma_f32_32x32x16_bf16 v[64:79], v[48:51], v[24:27], v[64:79]
  ds_read_b128 v[16:19], v124
  ds_read_b128 v[32:35], v10 offset:49152
  v_mfma_f32_32x32x16_bf16 v[80:95], v[52:55], v[24:27], v[80:95]
  ds_read_b128 v[36:39], v10 offset:53248
  s_waitcnt lgkmcnt(3)
  v_mfma_f32_32x32x16_bf16 v[64:79], v[56:59], v[28:31], v[64:79]
  ds_read_b128 v[20:23], v125
  ds_read_b128 v[40:43], v11 offset:49152
  v_mfma_f32_32x32x16_bf16 v[80:95], v[60:63], v[28:31], v[80:95]
  ds_read_b128 v[44:47], v11 offset:53248
  s_mov_b32 s52, s90
  v_add_u32 v120, s52, v116
  v_add_u32 v121, s52, v117
  v_add_u32 v122, s52, v118
  v_add_u32 v123, s52, v119
  s_barrier
  s_waitcnt lgkmcnt(3)
  v_mfma_f32_32x32x16_bf16 v[64:79], v[32:35], v[16:19], v[64:79]
  s_add_u32 s90, s52, 16384
  s_cmp_eq_u32 s90, 81920
  s_cselect_b32 s90, 0, s90
  v_add_u32 v124, s90, v116
  v_add_u32 v125, s90, v117
  ds_read_b128 v[24:27], v122
  ds_read_b128 v[48:51], v12 offset:49152
  v_mfma_f32_32x32x16_bf16 v[80:95], v[36:39], v[16:19], v[80:95]
  ds_read_b128 v[52:55], v12 offset:53248
  s_waitcnt lgkmcnt(3)
  v_mfma_f32_32x32x16_bf16 v[64:79], v[40:43], v[20:23], v[64:79]
  ds_read_b128 v[28:31], v123
  ds_read_b128 v[56:59], v13 offset:49152
  v_mfma_f32_32x32x16_bf16 v[80:95], v[44:47], v[20:23], v[80:95]
  ds_read_b128 v[60:63], v13 offset:53248
  s_waitcnt lgkmcnt(3)
  v_mfma_f32_32x32x16_bf16 v[64:79], v[48:51], v[24:27], v[64:79]
  ds_read_b128 v[16:19], v124
  ds_read_b128 v[32:35], v10 offset:57344
  v_mfma_f32_32x32x16_bf16 v[80:95], v[52:55], v[24:27], v[80:95]
  ds_read_b128 v[36:39], v10 offset:61440
  s_waitcnt lgkmcnt(3)
  v_mfma_f32_32x32x16_bf16 v[64:79], v[56:59], v[28:31], v[64:79]
  ds_read_b128 v[20:23], v125
  ds_read_b128 v[40:43], v11 offset:57344
  v_mfma_f32_32x32x16_bf16 v[80:95], v[60:63], v[28:31], v[80:95]
  ds_read_b128 v[44:47], v11 offset:61440
  s_mov_b32 s52, s90
  v_add_u32 v120, s52, v116
  v_add_u32 v121, s52, v117
  v_add_u32 v122, s52, v118
  v_add_u32 v123, s52, v119
  s_barrier
  s_waitcnt lgkmcnt(3)
  v_mfma_f32_32x32x16_bf16 v[64:79], v[32:35], v[16:19], v[64:79]
  s_add_u32 s90, s52, 16384
  s_cmp_eq_u32 s90, 81920
  s_cselect_b32 s90, 0, s90
  v_add_u32 v124, s90, v116
  v_add_u32 v125, s90, v117
  ds_read_b128 v[24:27], v122
  ds_read_b128 v[48:51], v12 offset:57344
  v_mfma_f32_32x32x16_bf16 v[80:95], v[36:39], v[16:19], v[80:95]
  ds_read_b128 v[52:55], v12 offset:61440
  s_waitcnt lgkmcnt(3)
  v_mfma_f32_32x32x16_bf16 v[64:79], v[40:43], v[20:23], v[64:79]
  ds_read_b128 v[28:31], v123
  ds_read_b128 v[56:59], v13 offset:57344
  v_mfma_f32_32x32x16_bf16 v[80:95], v[44:47], v[20:23], v[80:95]
  ds_read_b128 v[60:63], v13 offset:61440
  s_waitcnt lgkmcnt(3)
  v_mfma_f32_32x32x16_bf16 v[64:79], v[48:51], v[24:27], v[64:79]
  ds_read_b128 v[16:19], v124
  ds_read_b128 v[32:35], v10 offset:0
  v_mfma_f32_32x32x16_bf16 v[80:95], v[52:55], v[24:27], v[80:95]
  ds_read_b128 v[36:39], v10 offset:4096
  s_waitcnt lgkmcnt(3)
  v_mfma_f32_32x32x16_bf16 v[64:79], v[56:59], v[28:31], v[64:79]
  ds_read_b128 v[20:23], v125
  ds_read_b128 v[40:43], v11 offset:0
  v_mfma_f32_32x32x16_bf16 v[80:95], v[60:63], v[28:31], v[80:95]
  ds_read_b128 v[44:47], v11 offset:4096
  s_mov_b32 s52, s90
  v_add_u32 v120, s52, v116
  v_add_u32 v121, s52, v117
  v_add_u32 v122, s52, v118
  v_add_u32 v123, s52, v119
  s_waitcnt lgkmcnt(0)
  s_cmp_lg_u32 s93, 0
  s_cbranch_scc1 L_passB3_done
  v_and_b32 v5, 7, v4
  v_xor_b32 v5, v5, v3
  v_lshlrev_b32 v5, 4, v5
  v_lshl_add_u32 v5, v4, 7, v5
  v_add_u32 v5, 151552, v5
  v_cvt_pk_bf16_f32 v16, v64, v65
  v_cvt_pk_bf16_f32 v17, v66, v67
  v_cvt_pk_bf16_f32 v18, v68, v69
  v_cvt_pk_bf16_f32 v19, v70, v71
  v_xor_b32 v6, 0, v5
  ds_write_b128 v6, v[16:19]
  v_cvt_pk_bf16_f32 v20, v72, v73
  v_cvt_pk_bf16_f32 v21, v74, v75
  v_cvt_pk_bf16_f32 v22, v76, v77
  v_cvt_pk_bf16_f32 v23, v78, v79
  v_xor_b32 v6, 32, v5
  ds_write_b128 v6, v[20:23]
  v_cvt_pk_bf16_f32 v24, v80, v81
  v_cvt_pk_bf16_f32 v25, v82, v83
  v_cvt_pk_bf16_f32 v26, v84, v85
  v_cvt_pk_bf16_f32 v27, v86, v87
  v_xor_b32 v6, 64, v5
  ds_write_b128 v6, v[24:27]
  v_cvt_pk_bf16_f32 v28, v88, v89
  v_cvt_pk_bf16_f32 v29, v90, v91
  v_cvt_pk_bf16_f32 v30, v92, v93
  v_cvt_pk_bf16_f32 v31, v94, v95
  v_xor_b32 v6, 96, v5
  ds_write_b128 v6, v[28:31]
  v_lshrrev_b32 v7, 3, v1
  v_and_b32 v8, 7, v1
  v_xor_b32 v6, v7, v8
  v_lshlrev_b32 v6, 4, v6
  v_lshl_add_u32 v6, v7, 7, v6
  v_add_u32 v6, 151552, v6
  s_waitcnt lgkmcnt(0)
  ds_read_b128 v[32:35], v6 offset:0
  ds_read_b128 v[36:39], v6 offset:1024
  ds_read_b128 v[40:43], v6 offset:2048
  ds_read_b128 v[44:47], v6 offset:3072
  v_lshlrev_b32 v7, 13, v7
  v_lshl_add_u32 v7, v8, 4, v7
  s_lshl_b32 s63, s45, 18
  s_lshl_b32 s3, s44, 7
  s_add_u32 s63, s63, s3
  s_add_u32 s63, s63, 0x400000
  s_waitcnt lgkmcnt(0)
  buffer_store_dwordx4 v[32:35], v7, s[28:31], s63 offen sc1
  s_add_u32 s63, s63, 65536
  buffer_store_dwordx4 v[36:39], v7, s[28:31], s63 offen sc1
  s_add_u32 s63, s63, 65536
  buffer_store_dwordx4 v[40:43], v7, s[28:31], s63 offen sc1
  s_add_u32 s63, s63, 65536
  buffer_store_dwordx4 v[44:47], v7, s[28:31], s63 offen sc1
  s_barrier
  v_mov_b32 v6, 0
  buffer_load_dword a8, v6, s[40:43], 0 offen sc1
  s_mov_b32 s93, 1
  s_branch L_pass3
L_passB3_done:
  v_and_b32 v5, 7, v4
  v_xor_b32 v5, v5, v3
  v_lshlrev_b32 v5, 4, v5
  v_lshl_add_u32 v5, v4, 7, v5
  v_add_u32 v5, 151552, v5
  v_cvt_pk_bf16_f32 v16, v64, v65
  v_cvt_pk_bf16_f32 v17, v66, v67
  v_cvt_pk_bf16_f32 v18, v68, v69
  v_cvt_pk_bf16_f32 v19, v70, v71
  v_xor_b32 v6, 0, v5
  ds_write_b128 v6, v[16:19]
  v_cvt_pk_bf16_f32 v20, v72, v73
  v_cvt_pk_bf16_f32 v21, v74, v75
  v_cvt_pk_bf16_f32 v22, v76, v77
  v_cvt_pk_bf16_f32 v23, v78, v79
  v_xor_b32 v6, 32, v5
  ds_write_b128 v6, v[20:23]
  v_cvt_pk_bf16_f32 v24, v80, v81
  v_cvt_pk_bf16_f32 v25, v82, v83
  v_cvt_pk_bf16_f32 v26, v84, v85
  v_cvt_pk_bf16_f32 v27, v86, v87
  v_xor_b32 v6, 64, v5
  ds_write_b128 v6, v[24:27]
  v_cvt_pk_bf16_f32 v28, v88, v89
  v_cvt_pk_bf16_f32 v29, v90, v91
  v_cvt_pk_bf16_f32 v30, v92, v93
  v_cvt_pk_bf16_f32 v31, v94, v95
  v_xor_b32 v6, 96, v5
  ds_write_b128 v6, v[28:31]
  v_lshrrev_b32 v7, 3, v1
  v_and_b32 v8, 7, v1
  v_xor_b32 v6, v7, v8
  v_lshlrev_b32 v6, 4, v6
  v_lshl_add_u32 v6, v7, 7, v6
  v_add_u32 v6, 151552, v6
  s_waitcnt lgkmcnt(0)
  ds_read_b128 v[32:35], v6 offset:0
  ds_read_b128 v[36:39], v6 offset:1024
  ds_read_b128 v[40:43], v6 offset:2048
  ds_read_b128 v[44:47], v6 offset:3072
  v_lshlrev_b32 v7, 13, v7
  v_lshl_add_u32 v7, v8, 4, v7
  s_lshl_b32 s63, s45, 18
  s_lshl_b32 s3, s44, 7
  s_add_u32 s63, s63, s3
  s_add_u32 s63, s63, 0x401000
  s_waitcnt lgkmcnt(0)
  buffer_store_dwordx4 v[32:35], v7, s[28:31], s63 offen sc1
  s_add_u32 s63, s63, 65536
  buffer_store_dwordx4 v[36:39], v7, s[28:31], s63 offen sc1
  s_add_u32 s63, s63, 65536
  buffer_store_dwordx4 v[40:43], v7, s[28:31], s63 offen sc1
  s_add_u32 s63, s63, 65536
  buffer_store_dwordx4 v[44:47], v7, s[28:31], s63 offen sc1
  s_waitcnt vmcnt(0)
  v_accvgpr_read_b32 v39, a8
  s_nop 0
  v_readfirstlane_b32 s49, v39
  s_nop 0
  s_cmp_lg_u32 s49, 0
  s_cbranch_scc1 L_hn_3
  v_mov_b32 v6, 0
  s_mov_b32 s98, 0
L_nonce_4:
  buffer_load_dword v5, v6, s[40:43], 0 offen sc1
  s_waitcnt vmcnt(0)
  v_readfirstlane_b32 s49, v5
  s_add_u32 s98, s98, 1
  s_cmp_gt_u32 s98, 0x8000
  s_cbranch_scc1 L_nonce_4_x
  s_cmp_eq_u32 s49, 0
  s_cbranch_scc1 L_nonce_4
L_nonce_4_x:
L_hn_3:
  s_lshl_b32 s63, s50, 7
  s_add_u32 s63, s63, 0x800c
  v_mov_b32 v5, s49
  v_mov_b32 v6, 0
  s_mov_b64 exec, 1
  buffer_store_dword v5, v6, s[28:31], s63 offen sc1
  s_mov_b64 exec, -1
  s_barrier
  s_barrier
L_c_join:
  v_lshlrev_b32 v35, 4, v1
  v_and_b32 v5, 15, v4
  v_xor_b32 v5, v5, v3
  v_lshlrev_b32 v5, 4, v5
  v_lshl_add_u32 v5, v4, 8, v5
  s_lshl_b32 s3, s46, 15
  v_add_u32 v104, s3, v5
  v_xor_b32 v105, 32, v104
  v_xor_b32 v106, 64, v104
  v_xor_b32 v107, 96, v104
  v_xor_b32 v108, 128, v104
  v_xor_b32 v109, 160, v104
  v_xor_b32 v110, 192, v104
  v_xor_b32 v111, 224, v104
  s_sub_u32 s91, s48, 64
  s_add_u32 s63, s46, 0
  s_cmp_ge_u32 s63, 3
  s_cselect_b32 s90, 3, 0
  s_sub_u32 s63, s63, s90
  s_lshl_b32 s90, s63, 10
  v_add_u32 v5, s90, v35
  v_mov_b32 v6, 0x80000000
  v_cmp_le_u32 vcc, s91, v4
  s_cmp_eq_u32 s63, 2
  s_cselect_b64 s[94:95], vcc, 0
  v_cndmask_b32 v32, v5, v6, s[94:95]
  s_add_u32 s63, s46, 1
  s_cmp_ge_u32 s63, 3
  s_cselect_b32 s90, 3, 0
  s_sub_u32 s63, s63, s90
  s_lshl_b32 s90, s63, 10
  v_add_u32 v5, s90, v35
  v_mov_b32 v6, 0x80000000
  v_cmp_le_u32 vcc, s91, v4
  s_cmp_eq_u32 s63, 2
  s_cselect_b64 s[94:95], vcc, 0
  v_cndmask_b32 v33, v5, v6, s[94:95]
  s_add_u32 s63, s46, 2
  s_cmp_ge_u32 s63, 3
  s_cselect_b32 s90, 3, 0
  s_sub_u32 s63, s63, s90
  s_lshl_b32 s90, s63, 10
  v_add_u32 v5, s90, v35
  v_mov_b32 v6, 0x80000000
  v_cmp_le_u32 vcc, s91, v4
  s_cmp_eq_u32 s63, 2
  s_cselect_b64 s[94:95], vcc, 0
  v_cndmask_b32 v34, v5, v6, s[94:95]
  s_lshl_b32 s3, s45, 5
  s_lshl_b32 s63, s46, 3
  s_add_u32 s3, s3, s63
  v_add_u32 v38, s3, v1
  v_lshlrev_b32 v38, 7, v38
  v_add_u32 v38, 0x8000, v38
  s_lshl_b32 s99, s45, 7
  s_lshl_b32 s3, s46, 5
  s_add_u32 s99, s99, s3
  s_mov_b32 s51, 0
  s_add_u32 s3, s51, 0
  s_and_b32 s3, s3, 3
  s_lshl_b32 s3, s3, 3
  s_add_u32 s3, s3, s99
  s_mul_i32 s3, s3, 3072
  s_add_u32 s67, s3, 0x100000
  s_add_u32 s3, s51, 1
  s_and_b32 s3, s3, 3
  s_lshl_b32 s3, s3, 3
  s_add_u32 s3, s3, s99
  s_mul_i32 s3, s3, 3072
  s_add_u32 s68, s3, 0x100000
  s_add_u32 s3, s51, 2
  s_and_b32 s3, s3, 3
  s_lshl_b32 s3, s3, 3
  s_add_u32 s3, s3, s99
  s_mul_i32 s3, s3, 3072
  s_add_u32 s69, s3, 0x100000
  s_add_u32 s3, s51, 3
  s_and_b32 s3, s3, 3
  s_lshl_b32 s3, s3, 3
  s_add_u32 s3, s3, s99
  s_mul_i32 s3, s3, 3072
  s_add_u32 s70, s3, 0x100000
  v_accvgpr_read_b32 v36, a9
  v_accvgpr_read_b32 v37, a10
  s_mov_b32 s98, 0
  s_mov_b32 exec_lo, 0xff
  s_mov_b32 exec_hi, 0x0
L_poll_5:
  buffer_load_dwordx4 v[16:19], v38, s[28:31], 0 offen sc1
  s_waitcnt vmcnt(0)
  v_cmp_ne_u32 vcc, s49, v16
  v_cmp_ne_u32 s[94:95], s49, v17
  s_nop 0
  s_or_b64 vcc, vcc, s[94:95]
  v_cmp_ne_u32 s[94:95], s49, v18
  s_nop 0
  s_or_b64 vcc, vcc, s[94:95]
  s_add_u32 s98, s98, 1
  s_cmp_gt_u32 s98, 0x8000
  s_cbranch_scc1 L_poll_5_x
  s_cbranch_vccz L_poll_5_x
  s_sleep 2
  s_branch L_poll_5
L_poll_5_x:
  s_mov_b64 exec, -1
  s_add_u32 s63, s67, 0
  buffer_load_dwordx4 a[96:99], v32, s[28:31], s63 offen sc1
  buffer_load_dwordx4 a[100:103], v33, s[28:31], s63 offen sc1
  buffer_load_dwordx4 a[104:107], v34, s[28:31], s63 offen sc1
  s_add_u32 s63, s67, 3072
  buffer_load_dwordx4 a[108:111], v32, s[28:31], s63 offen sc1
  buffer_load_dwordx4 a[112:115], v33, s[28:31], s63 offen sc1
  buffer_load_dwordx4 a[116:119], v34, s[28:31], s63 offen sc1
  s_add_u32 s63, s67, 6144
  buffer_load_dwordx4 a[120:123], v32, s[28:31], s63 offen sc1
  buffer_load_dwordx4 a[124:127], v33, s[28:31], s63 offen sc1
  buffer_load_dwordx4 v[40:43], v34, s[28:31], s63 offen sc1
  s_add_u32 s63, s67, 9216
  buffer_load_dwordx4 v[44:47], v32, s[28:31], s63 offen sc1
  buffer_load_dwordx4 v[48:51], v33, s[28:31], s63 offen sc1
  buffer_load_dwordx4 v[52:55], v34, s[28:31], s63 offen sc1
  s_add_u32 s63, s67, 12288
  buffer_load_dwordx4 v[56:59], v32, s[28:31], s63 offen sc1
  buffer_load_dwordx4 v[60:63], v33, s[28:31], s63 offen sc1
  buffer_load_dwordx4 v[64:67], v34, s[28:31], s63 offen sc1
  s_add_u32 s63, s67, 15360
  buffer_load_dwordx4 v[68:71], v32, s[28:31], s63 offen sc1
  buffer_load_dwordx4 v[72:75], v33, s[28:31], s63 offen sc1
  buffer_load_dwordx4 v[76:79], v34, s[28:31], s63 offen sc1
  s_add_u32 s63, s67, 18432
  buffer_load_dwordx4 v[80:83], v32, s[28:31], s63 offen sc1
  buffer_load_dwordx4 v[84:87], v33, s[28:31], s63 offen sc1
  buffer_load_dwordx4 v[88:91], v34, s[28:31], s63 offen sc1
  s_add_u32 s63, s67, 21504
  buffer_load_dwordx4 v[92:95], v32, s[28:31], s63 offen sc1
  buffer_load_dwordx4 v[96:99], v33, s[28:31], s63 offen sc1
  buffer_load_dwordx4 v[100:103], v34, s[28:31], s63 offen sc1
  s_lshl_b32 s3, s46, 2
  s_add_u32 s3, s3, 149504
  v_mov_b32 v14, s3
  s_mov_b32 s98, 0
L_ld_6:
  ds_read_b32 v15, v14 offset:16
  s_waitcnt lgkmcnt(0)
  v_readfirstlane_b32 s90, v15
  s_add_u32 s98, s98, 1
  s_cmp_gt_u32 s98, 0x100000
  s_cbranch_scc1 L_ld_6_x
  s_cmp_lt_u32 s90, 1
  s_cbranch_scc1 L_ld_6
L_ld_6_x:
  ds_read_b128 v[16:19], v104 offset:0
  ds_read_b128 v[20:23], v104 offset:8192
  s_waitcnt vmcnt(21)
  s_waitcnt lgkmcnt(0)
  v_mfma_f32_32x32x16_bf16 a[0:15], a[96:99], v[16:19], 0
  ds_read_b128 v[24:27], v105 offset:0
  ds_read_b128 v[28:31], v105 offset:8192
  s_add_u32 s63, s68, 0
  v_mfma_f32_32x32x16_bf16 a[16:31], a[96:99], v[20:23], 0
  buffer_load_dwordx4 a[96:99], v32, s[28:31], s63 offen sc1
  v_mfma_f32_32x32x16_bf16 a[32:47], a[100:103], v[16:19], 0
  v_mfma_f32_32x32x16_bf16 a[48:63], a[100:103], v[20:23], 0
  buffer_load_dwordx4 a[100:103], v33, s[28:31], s63 offen sc1
  v_mfma_f32_32x32x16_bf16 a[64:79], a[104:107], v[16:19], 0
  v_mfma_f32_32x32x16_bf16 a[80:95], a[104:107], v[20:23], 0
  buffer_load_dwordx4 a[104:107], v34, s[28:31], s63 offen sc1
  s_waitcnt vmcnt(21)
  s_waitcnt lgkmcnt(0)
  v_mfma_f32_32x32x16_bf16 a[0:15], a[108:111], v[24:27], a[0:15]
  ds_read_b128 v[16:19], v106 offset:0
  ds_read_b128 v[20:23], v106 offset:8192
  s_add_u32 s63, s68, 3072
  v_mfma_f32_32x32x16_bf16 a[16:31], a[108:111], v[28:31], a[16:31]
  buffer_load_dwordx4 a[108:111], v32, s[28:31], s63 offen sc1
  v_mfma_f32_32x32x16_bf16 a[32:47], a[112:115], v[24:27], a[32:47]
  v_mfma_f32_32x32x16_bf16 a[48:63], a[112:115], v[28:31], a[48:63]
  buffer_load_dwordx4 a[112:115], v33, s[28:31], s63 offen sc1
  v_mfma_f32_32x32x16_bf16 a[64:79], a[116:119], v[24:27], a[64:79]
  v_mfma_f32_32x32x16_bf16 a[80:95], a[116:119], v[28:31], a[80:95]
  buffer_load_dwordx4 a[116:119], v34, s[28:31], s63 offen sc1
  s_waitcnt vmcnt(21)
  s_waitcnt lgkmcnt(0)
  v_mfma_f32_32x32x16_bf16 a[0:15], a[120:123], v[16:19], a[0:15]
  ds_read_b128 v[24:27], v107 offset:0
  ds_read_b128 v[28:31], v107 offset:8192
  s_add_u32 s63, s68, 6144
  v_mfma_f32_32x32x16_bf16 a[16:31], a[120:123], v[20:23], a[16:31]
  buffer_load_dwordx4 a[120:123], v32, s[28:31], s63 offen sc1
  v_mfma_f32_32x32x16_bf16 a[32:47], a[124:127], v[16:19], a[32:47]
  v_mfma_f32_32x32x16_bf16 a[48:63], a[124:127], v[20:23], a[48:63]
  buffer_load_dwordx4 a[124:127], v33, s[28:31], s63 offen sc1
  v_mfma_f32_32x32x16_bf16 a[64:79], v[40:43], v[16:19], a[64:79]
  v_mfma_f32_32x32x16_bf16 a[80:95], v[40:43], v[20:23], a[80:95]
  buffer_load_dwordx4 v[40:43], v34, s[28:31], s63 offen sc1
  s_waitcnt vmcnt(21)
  s_waitcnt lgkmcnt(0)
  v_mfma_f32_32x32x16_bf16 a[0:15], v[44:47], v[24:27], a[0:15]
  ds_read_b128 v[16:19], v108 offset:0
  ds_read_b128 v[20:23], v108 offset:8192
  s_add_u32 s63, s68, 9216
  v_mfma_f32_32x32x16_bf16 a[16:31], v[44:47], v[28:31], a[16:31]
  buffer_load_dwordx4 v[44:47], v32, s[28:31], s63 offen sc1
  v_mfma_f32_32x32x16_bf16 a[32:47], v[48:51], v[24:27], a[32:47]
  v_mfma_f32_32x32x16_bf16 a[48:63], v[48:51], v[28:31], a[48:63]
  buffer_load_dwordx4 v[48:51], v33, s[28:31], s63 offen sc1
  v_mfma_f32_32x32x16_bf16 a[64:79], v[52:55], v[24:27], a[64:79]
  v_mfma_f32_32x32x16_bf16 a[80:95], v[52:55], v[28:31], a[80:95]
  buffer_load_dwordx4 v[52:55], v34, s[28:31], s63 offen sc1
  s_waitcnt vmcnt(21)
  s_waitcnt lgkmcnt(0)
  v_mfma_f32_32x32x16_bf16 a[0:15], v[56:59], v[16:19], a[0:15]
  ds_read_b128 v[24:27], v109 offset:0
  ds_read_b128 v[28:31], v109 offset:8192
  s_add_u32 s63, s68, 12288
  v_mfma_f32_32x32x16_bf16 a[16:31], v[56:59], v[20:23], a[16:31]
  buffer_load_dwordx4 v[56:59], v32, s[28:31], s63 offen sc1
  v_mfma_f32_32x32x16_bf16 a[32:47], v[60:63], v[16:19], a[32:47]
  v_mfma_f32_32x32x16_bf16 a[48:63], v[60:63], v[20:23], a[48:63]
  buffer_load_dwordx4 v[60:63], v33, s[28:31], s63 offen sc1
  v_mfma_f32_32x32x16_bf16 a[64:79], v[64:67], v[16:19], a[64:79]
  v_mfma_f32_32x32x16_bf16 a[80:95], v[64:67], v[20:23], a[80:95]
  buffer_load_dwordx4 v[64:67], v34, s[28:31], s63 offen sc1
  s_waitcnt vmcnt(21)
  s_waitcnt lgkmcnt(0)
  v_mfma_f32_32x32x16_bf16 a[0:15], v[68:71], v[24:27], a[0:15]
  ds_read_b128 v[16:19], v110 offset:0
  ds_read_b128 v[20:23], v110 offset:8192
  s_add_u32 s63, s68, 15360
  v_mfma_f32_32x32x16_bf16 a[16:31], v[68:71], v[28:31], a[16:31]
  buffer_load_dwordx4 v[68:71], v32, s[28:31], s63 offen sc1
  v_mfma_f32_32x32x16_bf16 a[32:47], v[72:75], v[24:27], a[32:47]
  v_mfma_f32_32x32x16_bf16 a[48:63], v[72:75], v[28:31], a[48:63]
  buffer_load_dwordx4 v[72:75], v33, s[28:31], s63 offen sc1
  v_mfma_f32_32x32x16_bf16 a[64:79], v[76:79], v[24:27], a[64:79]
  v_mfma_f32_32x32x16_bf16 a[80:95], v[76:79], v[28:31], a[80:95]
  buffer_load_dwordx4 v[76:79], v34, s[28:31], s63 offen sc1
  s_waitcnt vmcnt(21)
  s_waitcnt lgkmcnt(0)
  v_mfma_f32_32x32x16_bf16 a[0:15], v[80:83], v[16:19], a[0:15]
  ds_read_b128 v[24:27], v111 offset:0
  ds_read_b128 v[28:31], v111 offset:8192
  ds_read_b32 v15, v14 offset:16
  s_add_u32 s63, s68, 18432
  v_mfma_f32_32x32x16_bf16 a[16:31], v[80:83], v[20:23], a[16:31]
  buffer_load_dwordx4 v[80:83], v32, s[28:31], s63 offen sc1
  v_mfma_f32_32x32x16_bf16 a[32:47], v[84:87], v[16:19], a[32:47]
  v_mfma_f32_32x32x16_bf16 a[48:63], v[84:87], v[20:23], a[48:63]
  buffer_load_dwordx4 v[84:87], v33, s[28:31], s63 offen sc1
  v_mfma_f32_32x32x16_bf16 a[64:79], v[88:91], v[16:19], a[64:79]
  v_mfma_f32_32x32x16_bf16 a[80:95], v[88:91], v[20:23], a[80:95]
  buffer_load_dwordx4 v[88:91], v34, s[28:31], s63 offen sc1
  s_waitcnt vmcnt(21)
  s_waitcnt lgkmcnt(0)
  v_readfirstlane_b32 s90, v15
  s_nop 0
  s_cmp_ge_u32 s90, 2
  s_cbranch_scc1 L_lp_7
  s_mov_b32 s98, 0
L_ld_8:
  ds_read_b32 v15, v14 offset:16
  s_waitcnt lgkmcnt(0)
  v_readfirstlane_b32 s90, v15
  s_add_u32 s98, s98, 1
  s_cmp_gt_u32 s98, 0x100000
  s_cbranch_scc1 L_ld_8_x
  s_cmp_lt_u32 s90, 2
  s_cbranch_scc1 L_ld_8
L_ld_8_x:
L_lp_7:
  v_mfma_f32_32x32x16_bf16 a[0:15], v[92:95], v[24:27], a[0:15]
  ds_read_b128 v[16:19], v104 offset:16384
  ds_read_b128 v[20:23], v104 offset:24576
  s_add_u32 s63, s68, 21504
  v_mfma_f32_32x32x16_bf16 a[16:31], v[92:95], v[28:31], a[16:31]
  buffer_load_dwordx4 v[92:95], v32, s[28:31], s63 offen sc1
  v_mfma_f32_32x32x16_bf16 a[32:47], v[96:99], v[24:27], a[32:47]
  v_mfma_f32_32x32x16_bf16 a[48:63], v[96:99], v[28:31], a[48:63]
  buffer_load_dwordx4 v[96:99], v33, s[28:31], s63 offen sc1
  v_mfma_f32_32x32x16_bf16 a[64:79], v[100:103], v[24:27], a[64:79]
  v_mfma_f32_32x32x16_bf16 a[80:95], v[100:103], v[28:31], a[80:95]
  buffer_load_dwordx4 v[100:103], v34, s[28:31], s63 offen sc1
  v_mov_b32 v15, 1
  ds_write_b32 v14, v15
  s_waitcnt vmcnt(21)
  s_waitcnt lgkmcnt(0)
  v_mfma_f32_32x32x16_bf16 a[0:15], a[96:99], v[16:19], a[0:15]
  ds_read_b128 v[24:27], v105 offset:16384
  ds_read_b128 v[28:31], v105 offset:24576
  s_add_u32 s63, s69, 0
  v_mfma_f32_32x32x16_bf16 a[16:31], a[96:99], v[20:23], a[16:31]
  buffer_load_dwordx4 a[96:99], v32, s[28:31], s63 offen sc1
  v_mfma_f32_32x32x16_bf16 a[32:47], a[100:103], v[16:19], a[32:47]
  v_mfma_f32_32x32x16_bf16 a[48:63], a[100:103], v[20:23], a[48:63]
  buffer_load_dwordx4 a[100:103], v33, s[28:31], s63 offen sc1
  v_mfma_f32_32x32x16_bf16 a[64:79], a[104:107], v[16:19], a[64:79]
  v_mfma_f32_32x32x16_bf16 a[80:95], a[104:107], v[20:23], a[80:95]
  buffer_load_dwordx4 a[104:107], v34, s[28:31], s63 offen sc1
  s_waitcnt vmcnt(21)
  s_waitcnt lgkmcnt(0)
  v_mfma_f32_32x32x16_bf16 a[0:15], a[108:111], v[24:27], a[0:15]
  ds_read_b128 v[16:19], v106 offset:16384
  ds_read_b128 v[20:23], v106 offset:24576
  s_add_u32 s63, s69, 3072
  v_mfma_f32_32x32x16_bf16 a[16:31], a[108:111], v[28:31], a[16:31]
  buffer_load_dwordx4 a[108:111], v32, s[28:31], s63 offen sc1
  v_mfma_f32_32x32x16_bf16 a[32:47], a[112:115], v[24:27], a[32:47]
  v_mfma_f32_32x32x16_bf16 a[48:63], a[112:115], v[28:31], a[48:63]
  buffer_load_dwordx4 a[112:115], v33, s[28:31], s63 offen sc1
  v_mfma_f32_32x32x16_bf16 a[64:79], a[116:119], v[24:27], a[64:79]
  v_mfma_f32_32x32x16_bf16 a[80:95], a[116:119], v[28:31], a[80:95]
  buffer_load_dwordx4 a[116:119], v34, s[28:31], s63 offen sc1
  s_waitcnt vmcnt(21)
  s_waitcnt lgkmcnt(0)
  v_mfma_f32_32x32x16_bf16 a[0:15], a[120:123], v[16:19], a[0:15]
  ds_read_b128 v[24:27], v107 offset:16384
  ds_read_b128 v[28:31], v107 offset:24576
  s_add_u32 s63, s69, 6144
  v_mfma_f32_32x32x16_bf16 a[16:31], a[120:123], v[20:23], a[16:31]
  buffer_load_dwordx4 a[120:123], v32, s[28:31], s63 offen sc1
  v_mfma_f32_32x32x16_bf16 a[32:47], a[124:127], v[16:19], a[32:47]
  v_mfma_f32_32x32x16_bf16 a[48:63], a[124:127], v[20:23], a[48:63]
  buffer_load_dwordx4 a[124:127], v33, s[28:31], s63 offen sc1
  v_mfma_f32_32x32x16_bf16 a[64:79], v[40:43], v[16:19], a[64:79]
  v_mfma_f32_32x32x16_bf16 a[80:95], v[40:43], v[20:23], a[80:95]
  buffer_load_dwordx4 v[40:43], v34, s[28:31], s63 offen sc1
  s_waitcnt vmcnt(21)
  s_waitcnt lgkmcnt(0)
  v_mfma_f32_32x32x16_bf16 a[0:15], v[44:47], v[24:27], a[0:15]
  ds_read_b128 v[16:19], v108 offset:16384
  ds_read_b128 v[20:23], v108 offset:24576
  s_add_u32 s63, s69, 9216
  v_mfma_f32_32x32x16_bf16 a[16:31], v[44:47], v[28:31], a[16:31]
  buffer_load_dwordx4 v[44:47], v32, s[28:31], s63 offen sc1
  v_mfma_f32_32x32x16_bf16 a[32:47], v[48:51], v[24:27], a[32:47]
  v_mfma_f32_32x32x16_bf16 a[48:63], v[48:51], v[28:31], a[48:63]
  buffer_load_dwordx4 v[48:51], v33, s[28:31], s63 offen sc1
  v_mfma_f32_32x32x16_bf16 a[64:79], v[52:55], v[24:27], a[64:79]
  v_mfma_f32_32x32x16_bf16 a[80:95], v[52:55], v[28:31], a[80:95]
  buffer_load_dwordx4 v[52:55], v34, s[28:31], s63 offen sc1
  s_waitcnt vmcnt(21)
  s_waitcnt lgkmcnt(0)
  v_mfma_f32_32x32x16_bf16 a[0:15], v[56:59], v[16:19], a[0:15]
  ds_read_b128 v[24:27], v109 offset:16384
  ds_read_b128 v[28:31], v109 offset:24576
  s_add_u32 s63, s69, 12288
  v_mfma_f32_32x32x16_bf16 a[16:31], v[56:59], v[20:23], a[16:31]
  buffer_load_dwordx4 v[56:59], v32, s[28:31], s63 offen sc1
  v_mfma_f32_32x32x16_bf16 a[32:47], v[60:63], v[16:19], a[32:47]
  v_mfma_f32_32x32x16_bf16 a[48:63], v[60:63], v[20:23], a[48:63]
  buffer_load_dwordx4 v[60:63], v33, s[28:31], s63 offen sc1
  v_mfma_f32_32x32x16_bf16 a[64:79], v[64:67], v[16:19], a[64:79]
  v_mfma_f32_32x32x16_bf16 a[80:95], v[64:67], v[20:23], a[80:95]
  buffer_load_dwordx4 v[64:67], v34, s[28:31], s63 offen sc1
  s_waitcnt vmcnt(21)
  s_waitcnt lgkmcnt(0)
  v_mfma_f32_32x32x16_bf16 a[0:15], v[68:71], v[24:27], a[0:15]
  ds_read_b128 v[16:19], v110 offset:16384
  ds_read_b128 v[20:23], v110 offset:24576
  s_add_u32 s63, s69, 15360
  v_mfma_f32_32x32x16_bf16 a[16:31], v[68:71], v[28:31], a[16:31]
  buffer_load_dwordx4 v[68:71], v32, s[28:31], s63 offen sc1
  v_mfma_f32_32x32x16_bf16 a[32:47], v[72:75], v[24:27], a[32:47]
  v_mfma_f32_32x32x16_bf16 a[48:63], v[72:75], v[28:31], a[48:63]
  buffer_load_dwordx4 v[72:75], v33, s[28:31], s63 offen sc1
  v_mfma_f32_32x32x16_bf16 a[64:79], v[76:79], v[24:27], a[64:79]
  v_mfma_f32_32x32x16_bf16 a[80:95], v[76:79], v[28:31], a[80:95]
  buffer_load_dwordx4 v[76:79], v34, s[28:31], s63 offen sc1
  s_waitcnt vmcnt(21)
  s_waitcnt lgkmcnt(0)
  v_mfma_f32_32x32x16_bf16 a[0:15], v[80:83], v[16:19], a[0:15]
  ds_read_b128 v[24:27], v111 offset:16384
  ds_read_b128 v[28:31], v111 offset:24576
  ds_read_b32 v15, v14 offset:16
  s_add_u32 s63, s69, 18432
  v_mfma_f32_32x32x16_bf16 a[16:31], v[80:83], v[20:23], a[16:31]
  buffer_load_dwordx4 v[80:83], v32, s[28:31], s63 offen sc1
  v_mfma_f32_32x32x16_bf16 a[32:47], v[84:87], v[16:19], a[32:47]
  v_mfma_f32_32x32x16_bf16 a[48:63], v[84:87], v[20:23], a[48:63]
  buffer_load_dwordx4 v[84:87], v33, s[28:31], s63 offen sc1
  v_mfma_f32_32x32x16_bf16 a[64:79], v[88:91], v[16:19], a[64:79]
  v_mfma_f32_32x32x16_bf16 a[80:95], v[88:91], v[20:23], a[80:95]
  buffer_load_dwordx4 v[88:91], v34, s[28:31], s63 offen sc1
  s_waitcnt vmcnt(21)
  s_waitcnt lgkmcnt(0)
  v_readfirstlane_b32 s90, v15
  s_nop 0
  s_cmp_ge_u32 s90, 3
  s_cbranch_scc1 L_lp_9
  s_mov_b32 s98, 0
L_ld_10:
  ds_read_b32 v15, v14 offset:16
  s_waitcnt lgkmcnt(0)
  v_readfirstlane_b32 s90, v15
  s_add_u32 s98, s98, 1
  s_cmp_gt_u32 s98, 0x100000
  s_cbranch_scc1 L_ld_10_x
  s_cmp_lt_u32 s90, 3
  s_cbranch_scc1 L_ld_10
L_ld_10_x:
L_lp_9:
  v_mfma_f32_32x32x16_bf16 a[0:15], v[92:95], v[24:27], a[0:15]
  ds_read_b128 v[16:19], v104 offset:0
  ds_read_b128 v[20:23], v104 offset:8192
  s_add_u32 s63, s69, 21504
  v_mfma_f32_32x32x16_bf16 a[16:31], v[92:95], v[28:31], a[16:31]
  buffer_load_dwordx4 v[92:95], v32, s[28:31], s63 offen sc1
  v_mfma_f32_32x32x16_bf16 a[32:47], v[96:99], v[24:27], a[32:47]
  v_mfma_f32_32x32x16_bf16 a[48:63], v[96:99], v[28:31], a[48:63]
  buffer_load_dwordx4 v[96:99], v33, s[28:31], s63 offen sc1
  v_mfma_f32_32x32x16_bf16 a[64:79], v[100:103], v[24:27], a[64:79]
  v_mfma_f32_32x32x16_bf16 a[80:95], v[100:103], v[28:31], a[80:95]
  buffer_load_dwordx4 v[100:103], v34, s[28:31], s63 offen sc1
  v_mov_b32 v15, 2
  ds_write_b32 v14, v15
  s_waitcnt vmcnt(21)
  s_waitcnt lgkmcnt(0)
  v_mfma_f32_32x32x16_bf16 a[0:15], a[96:99], v[16:19], a[0:15]
  ds_read_b128 v[24:27], v105 offset:0
  ds_read_b128 v[28:31], v105 offset:8192
  s_add_u32 s63, s70, 0
  v_mfma_f32_32x32x16_bf16 a[16:31], a[96:99], v[20:23], a[16:31]
  buffer_load_dwordx4 a[96:99], v32, s[28:31], s63 offen sc1
  v_mfma_f32_32x32x16_bf16 a[32:47], a[100:103], v[16:19], a[32:47]
  v_mfma_f32_32x32x16_bf16 a[48:63], a[100:103], v[20:23], a[48:63]
  buffer_load_dwordx4 a[100:103], v33, s[28:31], s63 offen sc1
  v_mfma_f32_32x32x16_bf16 a[64:79], a[104:107], v[16:19], a[64:79]
  v_mfma_f32_32x32x16_bf16 a[80:95], a[104:107], v[20:23], a[80:95]
  buffer_load_dwordx4 a[104:107], v34, s[28:31], s63 offen sc1
  s_waitcnt vmcnt(21)
  s_waitcnt lgkmcnt(0)
  v_mfma_f32_32x32x16_bf16 a[0:15], a[108:111], v[24:27], a[0:15]
  ds_read_b128 v[16:19], v106 offset:0
  ds_read_b128 v[20:23], v106 offset:8192
  s_add_u32 s63, s70, 3072
  v_mfma_f32_32x32x16_bf16 a[16:31], a[108:111], v[28:31], a[16:31]
  buffer_load_dwordx4 a[108:111], v32, s[28:31], s63 offen sc1
  v_mfma_f32_32x32x16_bf16 a[32:47], a[112:115], v[24:27], a[32:47]
  v_mfma_f32_32x32x16_bf16 a[48:63], a[112:115], v[28:31], a[48:63]
  buffer_load_dwordx4 a[112:115], v33, s[28:31], s63 offen sc1
  v_mfma_f32_32x32x16_bf16 a[64:79], a[116:119], v[24:27], a[64:79]
  v_mfma_f32_32x32x16_bf16 a[80:95], a[116:119], v[28:31], a[80:95]
  buffer_load_dwordx4 a[116:119], v34, s[28:31], s63 offen sc1
  s_waitcnt vmcnt(21)
  s_waitcnt lgkmcnt(0)
  v_mfma_f32_32x32x16_bf16 a[0:15], a[120:123], v[16:19], a[0:15]
  ds_read_b128 v[24:27], v107 offset:0
  ds_read_b128 v[28:31], v107 offset:8192
  s_add_u32 s63, s70, 6144
  v_mfma_f32_32x32x16_bf16 a[16:31], a[120:123], v[20:23], a[16:31]
  buffer_load_dwordx4 a[120:123], v32, s[28:31], s63 offen sc1
  v_mfma_f32_32x32x16_bf16 a[32:47], a[124:127], v[16:19], a[32:47]
  v_mfma_f32_32x32x16_bf16 a[48:63], a[124:127], v[20:23], a[48:63]
  buffer_load_dwordx4 a[124:127], v33, s[28:31], s63 offen sc1
  v_mfma_f32_32x32x16_bf16 a[64:79], v[40:43], v[16:19], a[64:79]
  v_mfma_f32_32x32x16_bf16 a[80:95], v[40:43], v[20:23], a[80:95]
  buffer_load_dwordx4 v[40:43], v34, s[28:31], s63 offen sc1
  s_waitcnt vmcnt(21)
  s_waitcnt lgkmcnt(0)
  v_mfma_f32_32x32x16_bf16 a[0:15], v[44:47], v[24:27], a[0:15]
  ds_read_b128 v[16:19], v108 offset:0
  ds_read_b128 v[20:23], v108 offset:8192
  s_add_u32 s63, s70, 9216
  v_mfma_f32_32x32x16_bf16 a[16:31], v[44:47], v[28:31], a[16:31]
  buffer_load_dwordx4 v[44:47], v32, s[28:31], s63 offen sc1
  v_mfma_f32_32x32x16_bf16 a[32:47], v[48:51], v[24:27], a[32:47]
  v_mfma_f32_32x32x16_bf16 a[48:63], v[48:51], v[28:31], a[48:63]
  buffer_load_dwordx4 v[48:51], v33, s[28:31], s63 offen sc1
  v_mfma_f32_32x32x16_bf16 a[64:79], v[52:55], v[24:27], a[64:79]
  v_mfma_f32_32x32x16_bf16 a[80:95], v[52:55], v[28:31], a[80:95]
  buffer_load_dwordx4 v[52:55], v34, s[28:31], s63 offen sc1
  s_waitcnt vmcnt(21)
  s_waitcnt lgkmcnt(0)
  v_mfma_f32_32x32x16_bf16 a[0:15], v[56:59], v[16:19], a[0:15]
  ds_read_b128 v[24:27], v109 offset:0
  ds_read_b128 v[28:31], v109 offset:8192
  s_add_u32 s63, s70, 12288
  v_mfma_f32_32x32x16_bf16 a[16:31], v[56:59], v[20:23], a[16:31]
  buffer_load_dwordx4 v[56:59], v32, s[28:31], s63 offen sc1
  v_mfma_f32_32x32x16_bf16 a[32:47], v[60:63], v[16:19], a[32:47]
  v_mfma_f32_32x32x16_bf16 a[48:63], v[60:63], v[20:23], a[48:63]
  buffer_load_dwordx4 v[60:63], v33, s[28:31], s63 offen sc1
  v_mfma_f32_32x32x16_bf16 a[64:79], v[64:67], v[16:19], a[64:79]
  v_mfma_f32_32x32x16_bf16 a[80:95], v[64:67], v[20:23], a[80:95]
  buffer_load_dwordx4 v[64:67], v34, s[28:31], s63 offen sc1
  s_waitcnt vmcnt(21)
  s_waitcnt lgkmcnt(0)
  v_mfma_f32_32x32x16_bf16 a[0:15], v[68:71], v[24:27], a[0:15]
  ds_read_b128 v[16:19], v110 offset:0
  ds_read_b128 v[20:23], v110 offset:8192
  s_add_u32 s63, s70, 15360
  v_mfma_f32_32x32x16_bf16 a[16:31], v[68:71], v[28:31], a[16:31]
  buffer_load_dwordx4 v[68:71], v32, s[28:31], s63 offen sc1
  v_mfma_f32_32x32x16_bf16 a[32:47], v[72:75], v[24:27], a[32:47]
  v_mfma_f32_32x32x16_bf16 a[48:63], v[72:75], v[28:31], a[48:63]
  buffer_load_dwordx4 v[72:75], v33, s[28:31], s63 offen sc1
  v_mfma_f32_32x32x16_bf16 a[64:79], v[76:79], v[24:27], a[64:79]
  v_mfma_f32_32x32x16_bf16 a[80:95], v[76:79], v[28:31], a[80:95]
  buffer_load_dwordx4 v[76:79], v34, s[28:31], s63 offen sc1
  s_waitcnt vmcnt(21)
  s_waitcnt lgkmcnt(0)
  v_mfma_f32_32x32x16_bf16 a[0:15], v[80:83], v[16:19], a[0:15]
  ds_read_b128 v[24:27], v111 offset:0
  ds_read_b128 v[28:31], v111 offset:8192
  ds_read_b32 v15, v14 offset:16
  s_add_u32 s63, s70, 18432
  v_mfma_f32_32x32x16_bf16 a[16:31], v[80:83], v[20:23], a[16:31]
  buffer_load_dwordx4 v[80:83], v32, s[28:31], s63 offen sc1
  v_mfma_f32_32x32x16_bf16 a[32:47], v[84:87], v[16:19], a[32:47]
  v_mfma_f32_32x32x16_bf16 a[48:63], v[84:87], v[20:23], a[48:63]
  buffer_load_dwordx4 v[84:87], v33, s[28:31], s63 offen sc1
  v_mfma_f32_32x32x16_bf16 a[64:79], v[88:91], v[16:19], a[64:79]
  v_mfma_f32_32x32x16_bf16 a[80:95], v[88:91], v[20:23], a[80:95]
  buffer_load_dwordx4 v[88:91], v34, s[28:31], s63 offen sc1
  s_waitcnt vmcnt(21)
  s_waitcnt lgkmcnt(0)
  v_readfirstlane_b32 s90, v15
  s_nop 0
  s_cmp_ge_u32 s90, 4
  s_cbranch_scc1 L_lp_11
  s_mov_b32 s98, 0
L_ld_12:
  ds_read_b32 v15, v14 offset:16
  s_waitcnt lgkmcnt(0)
  v_readfirstlane_b32 s90, v15
  s_add_u32 s98, s98, 1
  s_cmp_gt_u32 s98, 0x100000
  s_cbranch_scc1 L_ld_12_x
  s_cmp_lt_u32 s90, 4
  s_cbranch_scc1 L_ld_12
L_ld_12_x:
L_lp_11:
  v_mfma_f32_32x32x16_bf16 a[0:15], v[92:95], v[24:27], a[0:15]
  ds_read_b128 v[16:19], v104 offset:16384
  ds_read_b128 v[20:23], v104 offset:24576
  s_add_u32 s63, s70, 21504
  v_mfma_f32_32x32x16_bf16 a[16:31], v[92:95], v[28:31], a[16:31]
  buffer_load_dwordx4 v[92:95], v32, s[28:31], s63 offen sc1
  v_mfma_f32_32x32x16_bf16 a[32:47], v[96:99], v[24:27], a[32:47]
  v_mfma_f32_32x32x16_bf16 a[48:63], v[96:99], v[28:31], a[48:63]
  buffer_load_dwordx4 v[96:99], v33, s[28:31], s63 offen sc1
  v_mfma_f32_32x32x16_bf16 a[64:79], v[100:103], v[24:27], a[64:79]
  v_mfma_f32_32x32x16_bf16 a[80:95], v[100:103], v[28:31], a[80:95]
  buffer_load_dwordx4 v[100:103], v34, s[28:31], s63 offen sc1
  s_waitcnt vmcnt(21)
  s_waitcnt lgkmcnt(0)
  v_mfma_f32_32x32x16_bf16 a[0:15], a[96:99], v[16:19], a[0:15]
  ds_read_b128 v[24:27], v105 offset:16384
  ds_read_b128 v[28:31], v105 offset:24576
  v_mfma_f32_32x32x16_bf16 a[16:31], a[96:99], v[20:23], a[16:31]
  v_mfma_f32_32x32x16_bf16 a[32:47], a[100:103], v[16:19], a[32:47]
  v_mfma_f32_32x32x16_bf16 a[48:63], a[100:103], v[20:23], a[48:63]
  v_mfma_f32_32x32x16_bf16 a[64:79], a[104:107], v[16:19], a[64:79]
  v_mfma_f32_32x32x16_bf16 a[80:95], a[104:107], v[20:23], a[80:95]
  s_waitcnt vmcnt(18)
  s_waitcnt lgkmcnt(0)
  v_mfma_f32_32x32x16_bf16 a[0:15], a[108:111], v[24:27], a[0:15]
  ds_read_b128 v[16:19], v106 offset:16384
  ds_read_b128 v[20:23], v106 offset:24576
  v_mfma_f32_32x32x16_bf16 a[16:31], a[108:111], v[28:31], a[16:31]
  v_mfma_f32_32x32x16_bf16 a[32:47], a[112:115], v[24:27], a[32:47]
  v_mfma_f32_32x32x16_bf16 a[48:63], a[112:115], v[28:31], a[48:63]
  v_mfma_f32_32x32x16_bf16 a[64:79], a[116:119], v[24:27], a[64:79]
  v_mfma_f32_32x32x16_bf16 a[80:95], a[116:119], v[28:31], a[80:95]
  s_waitcnt vmcnt(15)
  s_waitcnt lgkmcnt(0)
  v_mfma_f32_32x32x16_bf16 a[0:15], a[120:123], v[16:19], a[0:15]
  ds_read_b128 v[24:27], v107 offset:16384
  ds_read_b128 v[28:31], v107 offset:24576
  v_mfma_f32_32x32x16_bf16 a[16:31], a[120:123], v[20:23], a[16:31]
  v_mfma_f32_32x32x16_bf16 a[32:47], a[124:127], v[16:19], a[32:47]
  v_mfma_f32_32x32x16_bf16 a[48:63], a[124:127], v[20:23], a[48:63]
  v_mfma_f32_32x32x16_bf16 a[64:79], v[40:43], v[16:19], a[64:79]
  v_mfma_f32_32x32x16_bf16 a[80:95], v[40:43], v[20:23], a[80:95]
  s_waitcnt vmcnt(12)
  s_waitcnt lgkmcnt(0)
  v_mfma_f32_32x32x16_bf16 a[0:15], v[44:47], v[24:27], a[0:15]
  ds_read_b128 v[16:19], v108 offset:16384
  ds_read_b128 v[20:23], v108 offset:24576
  v_mfma_f32_32x32x16_bf16 a[16:31], v[44:47], v[28:31], a[16:31]
  v_mfma_f32_32x32x16_bf16 a[32:47], v[48:51], v[24:27], a[32:47]
  v_mfma_f32_32x32x16_bf16 a[48:63], v[48:51], v[28:31], a[48:63]
  v_mfma_f32_32x32x16_bf16 a[64:79], v[52:55], v[24:27], a[64:79]
  v_mfma_f32_32x32x16_bf16 a[80:95], v[52:55], v[28:31], a[80:95]
  s_waitcnt vmcnt(9)
  s_waitcnt lgkmcnt(0)
  v_mfma_f32_32x32x16_bf16 a[0:15], v[56:59], v[16:19], a[0:15]
  ds_read_b128 v[24:27], v109 offset:16384
  ds_read_b128 v[28:31], v109 offset:24576
  v_mfma_f32_32x32x16_bf16 a[16:31], v[56:59], v[20:23], a[16:31]
  v_mfma_f32_32x32x16_bf16 a[32:47], v[60:63], v[16:19], a[32:47]
  v_mfma_f32_32x32x16_bf16 a[48:63], v[60:63], v[20:23], a[48:63]
  v_mfma_f32_32x32x16_bf16 a[64:79], v[64:67], v[16:19], a[64:79]
  v_mfma_f32_32x32x16_bf16 a[80:95], v[64:67], v[20:23], a[80:95]
  s_waitcnt vmcnt(6)
  s_waitcnt lgkmcnt(0)
  v_mfma_f32_32x32x16_bf16 a[0:15], v[68:71], v[24:27], a[0:15]
  ds_read_b128 v[16:19], v110 offset:16384
  ds_read_b128 v[20:23], v110 offset:24576
  v_mfma_f32_32x32x16_bf16 a[16:31], v[68:71], v[28:31], a[16:31]
  v_mfma_f32_32x32x16_bf16 a[32:47], v[72:75], v[24:27], a[32:47]
  v_mfma_f32_32x32x16_bf16 a[48:63], v[72:75], v[28:31], a[48:63]
  v_mfma_f32_32x32x16_bf16 a[64:79], v[76:79], v[24:27], a[64:79]
  v_mfma_f32_32x32x16_bf16 a[80:95], v[76:79], v[28:31], a[80:95]
  s_waitcnt vmcnt(3)
  s_waitcnt lgkmcnt(0)
  v_mfma_f32_32x32x16_bf16 a[0:15], v[80:83], v[16:19], a[0:15]
  ds_read_b128 v[24:27], v111 offset:16384
  ds_read_b128 v[28:31], v111 offset:24576
  v_mfma_f32_32x32x16_bf16 a[16:31], v[80:83], v[20:23], a[16:31]
  v_mfma_f32_32x32x16_bf16 a[32:47], v[84:87], v[16:19], a[32:47]
  v_mfma_f32_32x32x16_bf16 a[48:63], v[84:87], v[20:23], a[48:63]
  v_mfma_f32_32x32x16_bf16 a[64:79], v[88:91], v[16:19], a[64:79]
  v_mfma_f32_32x32x16_bf16 a[80:95], v[88:91], v[20:23], a[80:95]
  s_waitcnt vmcnt(0)
  s_waitcnt lgkmcnt(0)
  v_mfma_f32_32x32x16_bf16 a[0:15], v[92:95], v[24:27], a[0:15]
  v_mfma_f32_32x32x16_bf16 a[16:31], v[92:95], v[28:31], a[16:31]
  v_mfma_f32_32x32x16_bf16 a[32:47], v[96:99], v[24:27], a[32:47]
  v_mfma_f32_32x32x16_bf16 a[48:63], v[96:99], v[28:31], a[48:63]
  v_mfma_f32_32x32x16_bf16 a[64:79], v[100:103], v[24:27], a[64:79]
  v_mfma_f32_32x32x16_bf16 a[80:95], v[100:103], v[28:31], a[80:95]
  s_barrier
  s_add_u32 s63, s46, 1
  s_cmp_ge_u32 s63, 3
  s_cselect_b32 s90, 3, 0
  s_sub_u32 s63, s63, s90
  s_sub_u32 s90, s46, s63
  s_sub_u32 s90, s90, 1
  s_and_b32 s90, s90, 3
  s_mul_i32 s63, s63, 3
  s_add_u32 s63, s63, s90
  s_lshl_b32 s63, s63, 13
  v_add_u32 v5, s63, v35
  ds_write_b128 v5, a[32:35] offset:0
  ds_write_b128 v5, a[36:39] offset:1024
  ds_write_b128 v5, a[40:43] offset:2048
  ds_write_b128 v5, a[44:47] offset:3072
  ds_write_b128 v5, a[48:51] offset:4096
  ds_write_b128 v5, a[52:55] offset:5120
  ds_write_b128 v5, a[56:59] offset:6144
  ds_write_b128 v5, a[60:63] offset:7168
  s_add_u32 s63, s46, 2
  s_cmp_ge_u32 s63, 3
  s_cselect_b32 s90, 3, 0
  s_sub_u32 s63, s63, s90
  s_sub_u32 s90, s46, s63
  s_sub_u32 s90, s90, 1
  s_and_b32 s90, s90, 3
  s_mul_i32 s63, s63, 3
  s_add_u32 s63, s63, s90
  s_lshl_b32 s63, s63, 13
  v_add_u32 v5, s63, v35
  ds_write_b128 v5, a[64:67] offset:0
  ds_write_b128 v5, a[68:71] offset:1024
  ds_write_b128 v5, a[72:75] offset:2048
  ds_write_b128 v5, a[76:79] offset:3072
  ds_write_b128 v5, a[80:83] offset:4096
  ds_write_b128 v5, a[84:87] offset:5120
  ds_write_b128 v5, a[88:91] offset:6144
  ds_write_b128 v5, a[92:95] offset:7168
  s_cmp_lg_u32 s46, 3
  s_cbranch_scc1 L_exp_done
  s_add_u32 s63, s46, 0
  s_cmp_ge_u32 s63, 3
  s_cselect_b32 s90, 3, 0
  s_sub_u32 s63, s63, s90
  s_sub_u32 s90, s46, s63
  s_sub_u32 s90, s90, 1
  s_and_b32 s90, s90, 3
  s_mul_i32 s63, s63, 3
  s_add_u32 s63, s63, s90
  s_lshl_b32 s63, s63, 13
  v_add_u32 v5, s63, v35
  ds_write_b128 v5, a[0:3] offset:0
  ds_write_b128 v5, a[4:7] offset:1024
  ds_write_b128 v5, a[8:11] offset:2048
  ds_write_b128 v5, a[12:15] offset:3072
  ds_write_b128 v5, a[16:19] offset:4096
  ds_write_b128 v5, a[20:23] offset:5120
  ds_write_b128 v5, a[24:27] offset:6144
  ds_write_b128 v5, a[28:31] offset:7168
L_exp_done:
  s_waitcnt lgkmcnt(0)
  s_barrier
  s_cmp_eq_u32 s46, 3
  s_cbranch_scc1 L_h_done
  s_mul_i32 s63, s46, 24576
  v_add_u32 v5, s63, v35
  ds_read_b128 v[40:43], v5 offset:0
  ds_read_b128 v[44:47], v5 offset:1024
  ds_read_b128 v[48:51], v5 offset:2048
  ds_read_b128 v[52:55], v5 offset:3072
  ds_read_b128 v[56:59], v5 offset:4096
  ds_read_b128 v[60:63], v5 offset:5120
  ds_read_b128 v[64:67], v5 offset:6144
  ds_read_b128 v[68:71], v5 offset:7168
  ds_read_b128 v[72:75], v5 offset:8192
  ds_read_b128 v[76:79], v5 offset:9216
  ds_read_b128 v[80:83], v5 offset:10240
  ds_read_b128 v[84:87], v5 offset:11264
  ds_read_b128 v[88:91], v5 offset:12288
  ds_read_b128 v[92:95], v5 offset:13312
  ds_read_b128 v[96:99], v5 offset:14336
  ds_read_b128 v[100:103], v5 offset:15360
  s_waitcnt lgkmcnt(0)
  v_pk_add_f32 v[40:41], v[40:41], v[72:73]
  v_pk_add_f32 v[42:43], v[42:43], v[74:75]
  v_pk_add_f32 v[44:45], v[44:45], v[76:77]
  v_pk_add_f32 v[46:47], v[46:47], v[78:79]
  v_pk_add_f32 v[48:49], v[48:49], v[80:81]
  v_pk_add_f32 v[50:51], v[50:51], v[82:83]
  v_pk_add_f32 v[52:53], v[52:53], v[84:85]
  v_pk_add_f32 v[54:55], v[54:55], v[86:87]
  v_pk_add_f32 v[56:57], v[56:57], v[88:89]
  v_pk_add_f32 v[58:59], v[58:59], v[90:91]
  v_pk_add_f32 v[60:61], v[60:61], v[92:93]
  v_pk_add_f32 v[62:63], v[62:63], v[94:95]
  v_pk_add_f32 v[64:65], v[64:65], v[96:97]
  v_pk_add_f32 v[66:67], v[66:67], v[98:99]
  v_pk_add_f32 v[68:69], v[68:69], v[100:101]
  v_pk_add_f32 v[70:71], v[70:71], v[102:103]
  ds_read_b128 v[72:75], v5 offset:16384
  ds_read_b128 v[76:79], v5 offset:17408
  ds_read_b128 v[80:83], v5 offset:18432
  ds_read_b128 v[84:87], v5 offset:19456
  ds_read_b128 v[88:91], v5 offset:20480
  ds_read_b128 v[92:95], v5 offset:21504
  ds_read_b128 v[96:99], v5 offset:22528
  ds_read_b128 v[100:103], v5 offset:23552
  v_accvgpr_read_b32 v16, a0
  v_accvgpr_read_b32 v17, a1
  v_accvgpr_read_b32 v18, a2
  v_accvgpr_read_b32 v19, a3
  v_accvgpr_read_b32 v20, a4
  v_accvgpr_read_b32 v21, a5
  v_accvgpr_read_b32 v22, a6
  v_accvgpr_read_b32 v23, a7
  v_pk_add_f32 v[40:41], v[40:41], v[16:17]
  v_pk_add_f32 v[42:43], v[42:43], v[18:19]
  v_pk_add_f32 v[44:45], v[44:45], v[20:21]
  v_pk_add_f32 v[46:47], v[46:47], v[22:23]
  v_accvgpr_read_b32 v16, a8
  v_accvgpr_read_b32 v17, a9
  v_accvgpr_read_b32 v18, a10
  v_accvgpr_read_b32 v19, a11
  v_accvgpr_read_b32 v20, a12
  v_accvgpr_read_b32 v21, a13
  v_accvgpr_read_b32 v22, a14
  v_accvgpr_read_b32 v23, a15
  v_pk_add_f32 v[48:49], v[48:49], v[16:17]
  v_pk_add_f32 v[50:51], v[50:51], v[18:19]
  v_pk_add_f32 v[52:53], v[52:53], v[20:21]
  v_pk_add_f32 v[54:55], v[54:55], v[22:23]
  v_accvgpr_read_b32 v16, a16
  v_accvgpr_read_b32 v17, a17
  v_accvgpr_read_b32 v18, a18
  v_accvgpr_read_b32 v19, a19
  v_accvgpr_read_b32 v20, a20
  v_accvgpr_read_b32 v21, a21
  v_accvgpr_read_b32 v22, a22
  v_accvgpr_read_b32 v23, a23
  v_pk_add_f32 v[56:57], v[56:57], v[16:17]
  v_pk_add_f32 v[58:59], v[58:59], v[18:19]
  v_pk_add_f32 v[60:61], v[60:61], v[20:21]
  v_pk_add_f32 v[62:63], v[62:63], v[22:23]
  v_accvgpr_read_b32 v16, a24
  v_accvgpr_read_b32 v17, a25
  v_accvgpr_read_b32 v18, a26
  v_accvgpr_read_b32 v19, a27
  v_accvgpr_read_b32 v20, a28
  v_accvgpr_read_b32 v21, a29
  v_accvgpr_read_b32 v22, a30
  v_accvgpr_read_b32 v23, a31
  v_pk_add_f32 v[64:65], v[64:65], v[16:17]
  v_pk_add_f32 v[66:67], v[66:67], v[18:19]
  v_pk_add_f32 v[68:69], v[68:69], v[20:21]
  v_pk_add_f32 v[70:71], v[70:71], v[22:23]
  s_waitcnt lgkmcnt(0)
  v_pk_add_f32 v[40:41], v[40:41], v[72:73]
  v_pk_add_f32 v[42:43], v[42:43], v[74:75]
  v_pk_add_f32 v[44:45], v[44:45], v[76:77]
  v_pk_add_f32 v[46:47], v[46:47], v[78:79]
  v_pk_add_f32 v[48:49], v[48:49], v[80:81]
  v_pk_add_f32 v[50:51], v[50:51], v[82:83]
  v_pk_add_f32 v[52:53], v[52:53], v[84:85]
  v_pk_add_f32 v[54:55], v[54:55], v[86:87]
  v_pk_add_f32 v[56:57], v[56:57], v[88:89]
  v_pk_add_f32 v[58:59], v[58:59], v[90:91]
  v_pk_add_f32 v[60:61], v[60:61], v[92:93]
  v_pk_add_f32 v[62:63], v[62:63], v[94:95]
  v_pk_add_f32 v[64:65], v[64:65], v[96:97]
  v_pk_add_f32 v[66:67], v[66:67], v[98:99]
  v_pk_add_f32 v[68:69], v[68:69], v[100:101]
  v_pk_add_f32 v[70:71], v[70:71], v[102:103]
  v_lshlrev_b32 v36, 16, v36
  v_lshlrev_b32 v37, 16, v37
  v_lshlrev_b32 v16, 16, v112
  v_and_b32 v17, 0xffff0000, v112
  v_pk_add_f32 v[40:41], v[40:41], v[36:37] op_sel:[0,0] op_sel_hi:[1,0]
  v_pk_mul_f32 v[40:41], v[40:41], v[16:17]
  v_cvt_pk_bf16_f32 v72, v40, v41
  v_lshlrev_b32 v18, 16, v113
  v_and_b32 v19, 0xffff0000, v113
  v_pk_add_f32 v[42:43], v[42:43], v[36:37] op_sel:[0,0] op_sel_hi:[1,0]
  v_pk_mul_f32 v[42:43], v[42:43], v[18:19]
  v_cvt_pk_bf16_f32 v73, v42, v43
  v_lshlrev_b32 v20, 16, v114
  v_and_b32 v21, 0xffff0000, v114
  v_pk_add_f32 v[44:45], v[44:45], v[36:37] op_sel:[0,0] op_sel_hi:[1,0]
  v_pk_mul_f32 v[44:45], v[44:45], v[20:21]
  v_cvt_pk_bf16_f32 v74, v44, v45
  v_lshlrev_b32 v22, 16, v115
  v_and_b32 v23, 0xffff0000, v115
  v_pk_add_f32 v[46:47], v[46:47], v[36:37] op_sel:[0,0] op_sel_hi:[1,0]
  v_pk_mul_f32 v[46:47], v[46:47], v[22:23]
  v_cvt_pk_bf16_f32 v75, v46, v47
  v_lshlrev_b32 v16, 16, v116
  v_and_b32 v17, 0xffff0000, v116
  v_pk_add_f32 v[48:49], v[48:49], v[36:37] op_sel:[0,0] op_sel_hi:[1,0]
  v_pk_mul_f32 v[48:49], v[48:49], v[16:17]
  v_cvt_pk_bf16_f32 v76, v48, v49
  v_lshlrev_b32 v18, 16, v117
  v_and_b32 v19, 0xffff0000, v117
  v_pk_add_f32 v[50:51], v[50:51], v[36:37] op_sel:[0,0] op_sel_hi:[1,0]
  v_pk_mul_f32 v[50:51], v[50:51], v[18:19]
  v_cvt_pk_bf16_f32 v77, v50, v51
  v_lshlrev_b32 v20, 16, v118
  v_and_b32 v21, 0xffff0000, v118
  v_pk_add_f32 v[52:53], v[52:53], v[36:37] op_sel:[0,0] op_sel_hi:[1,0]
  v_pk_mul_f32 v[52:53], v[52:53], v[20:21]
  v_cvt_pk_bf16_f32 v78, v52, v53
  v_lshlrev_b32 v22, 16, v119
  v_and_b32 v23, 0xffff0000, v119
  v_pk_add_f32 v[54:55], v[54:55], v[36:37] op_sel:[0,0] op_sel_hi:[1,0]
  v_pk_mul_f32 v[54:55], v[54:55], v[22:23]
  v_cvt_pk_bf16_f32 v79, v54, v55
  v_lshlrev_b32 v16, 16, v120
  v_and_b32 v17, 0xffff0000, v120
  v_pk_add_f32 v[56:57], v[56:57], v[36:37] op_sel:[0,1] op_sel_hi:[1,1]
  v_pk_mul_f32 v[56:57], v[56:57], v[16:17]
  v_cvt_pk_bf16_f32 v80, v56, v57
  v_lshlrev_b32 v18, 16, v121
  v_and_b32 v19, 0xffff0000, v121
  v_pk_add_f32 v[58:59], v[58:59], v[36:37] op_sel:[0,1] op_sel_hi:[1,1]
  v_pk_mul_f32 v[58:59], v[58:59], v[18:19]
  v_cvt_pk_bf16_f32 v81, v58, v59
  v_lshlrev_b32 v20, 16, v122
  v_and_b32 v21, 0xffff0000, v122
  v_pk_add_f32 v[60:61], v[60:61], v[36:37] op_sel:[0,1] op_sel_hi:[1,1]
  v_pk_mul_f32 v[60:61], v[60:61], v[20:21]
  v_cvt_pk_bf16_f32 v82, v60, v61
  v_lshlrev_b32 v22, 16, v123
  v_and_b32 v23, 0xffff0000, v123
  v_pk_add_f32 v[62:63], v[62:63], v[36:37] op_sel:[0,1] op_sel_hi:[1,1]
  v_pk_mul_f32 v[62:63], v[62:63], v[22:23]
  v_cvt_pk_bf16_f32 v83, v62, v63
  v_lshlrev_b32 v16, 16, v124
  v_and_b32 v17, 0xffff0000, v124
  v_pk_add_f32 v[64:65], v[64:65], v[36:37] op_sel:[0,1] op_sel_hi:[1,1]
  v_pk_mul_f32 v[64:65], v[64:65], v[16:17]
  v_cvt_pk_bf16_f32 v84, v64, v65
  v_lshlrev_b32 v18, 16, v125
  v_and_b32 v19, 0xffff0000, v125
  v_pk_add_f32 v[66:67], v[66:67], v[36:37] op_sel:[0,1] op_sel_hi:[1,1]
  v_pk_mul_f32 v[66:67], v[66:67], v[18:19]
  v_cvt_pk_bf16_f32 v85, v66, v67
  v_lshlrev_b32 v20, 16, v126
  v_and_b32 v21, 0xffff0000, v126
  v_pk_add_f32 v[68:69], v[68:69], v[36:37] op_sel:[0,1] op_sel_hi:[1,1]
  v_pk_mul_f32 v[68:69], v[68:69], v[20:21]
  v_cvt_pk_bf16_f32 v86, v68, v69
  v_lshlrev_b32 v22, 16, v127
  v_and_b32 v23, 0xffff0000, v127
  v_pk_add_f32 v[70:71], v[70:71], v[36:37] op_sel:[0,1] op_sel_hi:[1,1]
  v_pk_mul_f32 v[70:71], v[70:71], v[22:23]
  v_cvt_pk_bf16_f32 v87, v70, v71
  s_mul_i32 s63, s44, 96
  s_mul_i32 s90, s45, 6
  s_add_u32 s63, s63, s90
  s_lshl_b32 s90, s46, 1
  s_add_u32 s63, s63, s90
  s_lshl_b32 s63, s63, 10
  s_add_u32 s63, s63, 0x600000
  s_add_u32 s90, s63, 0
  buffer_store_dwordx4 v[72:75], v35, s[28:31], s90 offen sc1
  s_add_u32 s90, s63, 1024
  buffer_store_dwordx4 v[76:79], v35, s[28:31], s90 offen sc1
  s_add_u32 s90, s63, 49152
  buffer_store_dwordx4 v[80:83], v35, s[28:31], s90 offen sc1
  s_add_u32 s90, s63, 50176
  buffer_store_dwordx4 v[84:87], v35, s[28:31], s90 offen sc1
  s_waitcnt vmcnt(0)
  s_lshl_b32 s63, s50, 7
  s_add_u32 s63, s63, 0x10000
  s_lshl_b32 s3, s46, 2
  s_add_u32 s63, s63, s3
  v_mov_b32 v5, s49
  v_mov_b32 v6, 0
  s_mov_b64 exec, 1
  buffer_store_dword v5, v6, s[28:31], s63 offen sc1
  s_mov_b64 exec, -1
L_h_done:
  s_lshr_b32 s63, s46, 1
  s_lshl_b32 s3, s63, 2
  v_add_u32 v40, s3, v1
  v_lshlrev_b32 v40, 5, v40
  v_add_u32 v40, s44, v40
  v_lshlrev_b32 v40, 7, v40
  v_add_u32 v40, 0x10000, v40
  v_bfe_u32 v5, v1, 2, 2
  v_lshl_add_u32 v5, v3, 3, v5
  v_lshlrev_b32 v5, 7, v5
  v_bfe_u32 v6, v1, 4, 1
  v_lshlrev_b32 v6, 1, v6
  v_and_b32 v7, 1, v1
  v_or_b32 v6, v6, v7
  v_bfe_u32 v7, v1, 3, 1
  v_lshlrev_b32 v7, 2, v7
  v_xor_b32 v6, v6, v7
  s_lshl_b32 s3, s63, 2
  v_xor_b32 v6, s3, v6
  v_bfe_u32 v7, v1, 1, 1
  v_lshlrev_b32 v7, 3, v7
  v_add_u32 v5, v5, v7
  s_mul_i32 s3, s63, 45056
  s_add_u32 s3, s3, 73728
  v_add_u32 v5, s3, v5
  v_lshl_add_u32 v52, v6, 4, v5
  v_xor_b32 v6, 4, v6
  v_lshl_add_u32 v53, v6, 4, v5
  s_cmp_eq_u32 s63, 0
  s_cselect_b32 s3, 8, 0
  s_add_u32 s3, s3, 256
  s_lshl_b32 s3, s3, 7
  v_add_u32 v54, s3, v52
  v_add_u32 v55, s3, v53
  s_and_b32 s90, s46, 1
  s_lshl_b32 s3, s44, 1
  s_add_u32 s3, s3, s90
  s_mul_i32 s3, s3, 48
  s_mul_i32 s99, s63, 24
  s_add_u32 s99, s99, s3
  s_lshl_b32 s99, s99, 10
  s_add_u32 s99, s99, 0x600000
  s_mov_b32 s98, 0
  s_mov_b32 exec_lo, 0xf
  s_mov_b32 exec_hi, 0x0
L_poll_13:
  buffer_load_dwordx4 v[60:63], v40, s[28:31], 0 offen sc1
  s_waitcnt vmcnt(0)
  v_cmp_ne_u32 vcc, s49, v60
  v_cmp_ne_u32 s[94:95], s49, v61
  s_nop 0
  s_or_b64 vcc, vcc, s[94:95]
  v_cmp_ne_u32 s[94:95], s49, v62
  s_nop 0
  s_or_b64 vcc, vcc, s[94:95]
  s_add_u32 s98, s98, 1
  s_cmp_gt_u32 s98, 0x8000
  s_cbranch_scc1 L_poll_13_x
  s_cbranch_vccz L_poll_13_x
  s_sleep 2
  s_branch L_poll_13
L_poll_13_x:
  s_mov_b64 exec, -1
  s_add_u32 s63, s99, 0
  buffer_load_dwordx4 a[32:35], v35, s[28:31], s63 offen sc1
  s_add_u32 s63, s99, 1024
  buffer_load_dwordx4 a[36:39], v35, s[28:31], s63 offen sc1
  s_add_u32 s63, s99, 2048
  buffer_load_dwordx4 a[40:43], v35, s[28:31], s63 offen sc1
  s_add_u32 s63, s99, 3072
  buffer_load_dwordx4 a[44:47], v35, s[28:31], s63 offen sc1
  s_add_u32 s63, s99, 4096
  buffer_load_dwordx4 a[48:51], v35, s[28:31], s63 offen sc1
  s_add_u32 s63, s99, 5120
  buffer_load_dwordx4 a[52:55], v35, s[28:31], s63 offen sc1
  s_add_u32 s63, s99, 6144
  buffer_load_dwordx4 a[56:59], v35, s[28:31], s63 offen sc1
  s_add_u32 s63, s99, 7168
  buffer_load_dwordx4 a[60:63], v35, s[28:31], s63 offen sc1
  s_barrier
  ds_read_b64_tr_b16 v[16:17], v52 offset:0
  ds_read_b64_tr_b16 v[18:19], v52 offset:512
  ds_read_b64_tr_b16 v[20:21], v53 offset:0
  ds_read_b64_tr_b16 v[22:23], v53 offset:512
  ds_read_b64_tr_b16 v[24:25], v52 offset:2048
  ds_read_b64_tr_b16 v[26:27], v52 offset:2560
  ds_read_b64_tr_b16 v[28:29], v53 offset:2048
  ds_read_b64_tr_b16 v[30:31], v53 offset:2560
  ds_read_b64_tr_b16 v[60:61], v52 offset:4096
  ds_read_b64_tr_b16 v[62:63], v52 offset:4608
  ds_read_b64_tr_b16 v[64:65], v53 offset:4096
  ds_read_b64_tr_b16 v[66:67], v53 offset:4608
  s_waitcnt vmcnt(7)
  s_waitcnt lgkmcnt(8)
  v_mfma_f32_32x32x16_bf16 a[0:15], v[16:19], a[32:35], 0
  ds_read_b64_tr_b16 v[68:69], v52 offset:6144
  ds_read_b64_tr_b16 v[70:71], v52 offset:6656
  s_add_u32 s63, s99, 8192
  buffer_load_dwordx4 a[64:67], v35, s[28:31], s63 offen sc1
  v_mfma_f32_32x32x16_bf16 a[16:31], v[20:23], a[32:35], 0
  ds_read_b64_tr_b16 v[72:73], v53 offset:6144
  ds_read_b64_tr_b16 v[74:75], v53 offset:6656
  s_waitcnt vmcnt(7)
  s_waitcnt lgkmcnt(8)
  v_mfma_f32_32x32x16_bf16 a[0:15], v[24:27], a[36:39], a[0:15]
  ds_read_b64_tr_b16 v[16:17], v52 offset:8192
  ds_read_b64_tr_b16 v[18:19], v52 offset:8704
  s_add_u32 s63, s99, 9216
  buffer_load_dwordx4 a[68:71], v35, s[28:31], s63 offen sc1
  v_mfma_f32_32x32x16_bf16 a[16:31], v[28:31], a[36:39], a[16:31]
  ds_read_b64_tr_b16 v[20:21], v53 offset:8192
  ds_read_b64_tr_b16 v[22:23], v53 offset:8704
  s_waitcnt vmcnt(7)
  s_waitcnt lgkmcnt(8)
  v_mfma_f32_32x32x16_bf16 a[0:15], v[60:63], a[40:43], a[0:15]
  ds_read_b64_tr_b16 v[24:25], v52 offset:10240
  ds_read_b64_tr_b16 v[26:27], v52 offset:10752
  s_add_u32 s63, s99, 10240
  buffer_load_dwordx4 a[72:75], v35, s[28:31], s63 offen sc1
  v_mfma_f32_32x32x16_bf16 a[16:31], v[64:67], a[40:43], a[16:31]
  ds_read_b64_tr_b16 v[28:29], v53 offset:10240
  ds_read_b64_tr_b16 v[30:31], v53 offset:10752
  s_waitcnt vmcnt(7)
  s_waitcnt lgkmcnt(8)
  v_mfma_f32_32x32x16_bf16 a[0:15], v[68:71], a[44:47], a[0:15]
  ds_read_b64_tr_b16 v[60:61], v52 offset:11264
  ds_read_b64_tr_b16 v[62:63], v52 offset:11776
  s_add_u32 s63, s99, 11264
  buffer_load_dwordx4 a[76:79], v35, s[28:31], s63 offen sc1
  v_mfma_f32_32x32x16_bf16 a[16:31], v[72:75], a[44:47], a[16:31]
  ds_read_b64_tr_b16 v[64:65], v53 offset:11264
  ds_read_b64_tr_b16 v[66:67], v53 offset:11776
  s_waitcnt vmcnt(7)
  s_waitcnt lgkmcnt(8)
  v_mfma_f32_32x32x16_bf16 a[0:15], v[16:19], a[48:51], a[0:15]
  ds_read_b64_tr_b16 v[68:69], v52 offset:13312
  ds_read_b64_tr_b16 v[70:71], v52 offset:13824
  s_add_u32 s63, s99, 12288
  buffer_load_dwordx4 a[80:83], v35, s[28:31], s63 offen sc1
  v_mfma_f32_32x32x16_bf16 a[16:31], v[20:23], a[48:51], a[16:31]
  ds_read_b64_tr_b16 v[72:73], v53 offset:13312
  ds_read_b64_tr_b16 v[74:75], v53 offset:13824
  s_waitcnt vmcnt(7)
  s_waitcnt lgkmcnt(8)
  v_mfma_f32_32x32x16_bf16 a[0:15], v[24:27], a[52:55], a[0:15]
  ds_read_b64_tr_b16 v[16:17], v52 offset:15360
  ds_read_b64_tr_b16 v[18:19], v52 offset:15872
  s_add_u32 s63, s99, 13312
  buffer_load_dwordx4 a[84:87], v35, s[28:31], s63 offen sc1
  v_mfma_f32_32x32x16_bf16 a[16:31], v[28:31], a[52:55], a[16:31]
  ds_read_b64_tr_b16 v[20:21], v53 offset:15360
  ds_read_b64_tr_b16 v[22:23], v53 offset:15872
  s_waitcnt vmcnt(7)
  s_waitcnt lgkmcnt(8)
  v_mfma_f32_32x32x16_bf16 a[0:15], v[60:63], a[56:59], a[0:15]
  ds_read_b64_tr_b16 v[24:25], v52 offset:17408
  ds_read_b64_tr_b16 v[26:27], v52 offset:17920
  s_add_u32 s63, s99, 14336
  buffer_load_dwordx4 a[88:91], v35, s[28:31], s63 offen sc1
  v_mfma_f32_32x32x16_bf16 a[16:31], v[64:67], a[56:59], a[16:31]
  ds_read_b64_tr_b16 v[28:29], v53 offset:17408
  ds_read_b64_tr_b16 v[30:31], v53 offset:17920
  s_waitcnt vmcnt(7)
  s_waitcnt lgkmcnt(8)
  v_mfma_f32_32x32x16_bf16 a[0:15], v[68:71], a[60:63], a[0:15]
  ds_read_b64_tr_b16 v[60:61], v52 offset:19456
  ds_read_b64_tr_b16 v[62:63], v52 offset:19968
  s_add_u32 s63, s99, 15360
  buffer_load_dwordx4 a[92:95], v35, s[28:31], s63 offen sc1
  v_mfma_f32_32x32x16_bf16 a[16:31], v[72:75], a[60:63], a[16:31]
  ds_read_b64_tr_b16 v[64:65], v53 offset:19456
  ds_read_b64_tr_b16 v[66:67], v53 offset:19968
  s_waitcnt vmcnt(7)
  s_waitcnt lgkmcnt(8)
  v_mfma_f32_32x32x16_bf16 a[0:15], v[16:19], a[64:67], a[0:15]
  ds_read_b64_tr_b16 v[68:69], v52 offset:21504
  ds_read_b64_tr_b16 v[70:71], v52 offset:22016
  s_add_u32 s63, s99, 16384
  buffer_load_dwordx4 a[96:99], v35, s[28:31], s63 offen sc1
  v_mfma_f32_32x32x16_bf16 a[16:31], v[20:23], a[64:67], a[16:31]
  ds_read_b64_tr_b16 v[72:73], v53 offset:21504
  ds_read_b64_tr_b16 v[74:75], v53 offset:22016
  s_waitcnt vmcnt(7)
  s_waitcnt lgkmcnt(8)
  v_mfma_f32_32x32x16_bf16 a[0:15], v[24:27], a[68:71], a[0:15]
  ds_read_b64_tr_b16 v[16:17], v52 offset:22528
  ds_read_b64_tr_b16 v[18:19], v52 offset:23040
  s_add_u32 s63, s99, 17408
  buffer_load_dwordx4 a[100:103], v35, s[28:31], s63 offen sc1
  v_mfma_f32_32x32x16_bf16 a[16:31], v[28:31], a[68:71], a[16:31]
  ds_read_b64_tr_b16 v[20:21], v53 offset:22528
  ds_read_b64_tr_b16 v[22:23], v53 offset:23040
  s_waitcnt vmcnt(7)
  s_waitcnt lgkmcnt(8)
  v_mfma_f32_32x32x16_bf16 a[0:15], v[60:63], a[72:75], a[0:15]
  ds_read_b64_tr_b16 v[24:25], v52 offset:24576
  ds_read_b64_tr_b16 v[26:27], v52 offset:25088
  s_add_u32 s63, s99, 18432
  buffer_load_dwordx4 a[104:107], v35, s[28:31], s63 offen sc1
  v_mfma_f32_32x32x16_bf16 a[16:31], v[64:67], a[72:75], a[16:31]
  ds_read_b64_tr_b16 v[28:29], v53 offset:24576
  ds_read_b64_tr_b16 v[30:31], v53 offset:25088
  s_waitcnt vmcnt(7)
  s_waitcnt lgkmcnt(8)
  v_mfma_f32_32x32x16_bf16 a[0:15], v[68:71], a[76:79], a[0:15]
  ds_read_b64_tr_b16 v[60:61], v52 offset:26624
  ds_read_b64_tr_b16 v[62:63], v52 offset:27136
  s_add_u32 s63, s99, 19456
  buffer_load_dwordx4 a[108:111], v35, s[28:31], s63 offen sc1
  v_mfma_f32_32x32x16_bf16 a[16:31], v[72:75], a[76:79], a[16:31]
  ds_read_b64_tr_b16 v[64:65], v53 offset:26624
  ds_read_b64_tr_b16 v[66:67], v53 offset:27136
  s_waitcnt vmcnt(7)
  s_waitcnt lgkmcnt(8)
  v_mfma_f32_32x32x16_bf16 a[0:15], v[16:19], a[80:83], a[0:15]
  ds_read_b64_tr_b16 v[68:69], v52 offset:28672
  ds_read_b64_tr_b16 v[70:71], v52 offset:29184
  s_add_u32 s63, s99, 20480
  buffer_load_dwordx4 a[112:115], v35, s[28:31], s63 offen sc1
  v_mfma_f32_32x32x16_bf16 a[16:31], v[20:23], a[80:83], a[16:31]
  ds_read_b64_tr_b16 v[72:73], v53 offset:28672
  ds_read_b64_tr_b16 v[74:75], v53 offset:29184
  s_waitcnt vmcnt(7)
  s_waitcnt lgkmcnt(8)
  v_mfma_f32_32x32x16_bf16 a[0:15], v[24:27], a[84:87], a[0:15]
  ds_read_b64_tr_b16 v[16:17], v52 offset:30720
  ds_read_b64_tr_b16 v[18:19], v52 offset:31232
  s_add_u32 s63, s99, 21504
  buffer_load_dwordx4 a[116:119], v35, s[28:31], s63 offen sc1
  v_mfma_f32_32x32x16_bf16 a[16:31], v[28:31], a[84:87], a[16:31]
  ds_read_b64_tr_b16 v[20:21], v53 offset:30720
  ds_read_b64_tr_b16 v[22:23], v53 offset:31232
  s_waitcnt vmcnt(7)
  s_waitcnt lgkmcnt(8)
  v_mfma_f32_32x32x16_bf16 a[0:15], v[60:63], a[88:91], a[0:15]
  ds_read_b64_tr_b16 v[24:25], v52 offset:32768
  ds_read_b64_tr_b16 v[26:27], v52 offset:33280
  s_add_u32 s63, s99, 22528
  buffer_load_dwordx4 a[120:123], v35, s[28:31], s63 offen sc1
  v_mfma_f32_32x32x16_bf16 a[16:31], v[64:67], a[88:91], a[16:31]
  ds_read_b64_tr_b16 v[28:29], v53 offset:32768
  ds_read_b64_tr_b16 v[30:31], v53 offset:33280
  s_waitcnt vmcnt(7)
  s_waitcnt lgkmcnt(8)
  v_mfma_f32_32x32x16_bf16 a[0:15], v[68:71], a[92:95], a[0:15]
  ds_read_b64_tr_b16 v[60:61], v54 offset:0
  ds_read_b64_tr_b16 v[62:63], v54 offset:512
  s_add_u32 s63, s99, 23552
  buffer_load_dwordx4 a[124:127], v35, s[28:31], s63 offen sc1
  v_mfma_f32_32x32x16_bf16 a[16:31], v[72:75], a[92:95], a[16:31]
  ds_read_b64_tr_b16 v[64:65], v55 offset:0
  ds_read_b64_tr_b16 v[66:67], v55 offset:512
  s_waitcnt vmcnt(7)
  s_waitcnt lgkmcnt(8)
  v_mfma_f32_32x32x16_bf16 a[0:15], v[16:19], a[96:99], a[0:15]
  ds_read_b64_tr_b16 v[68:69], v54 offset:2048
  ds_read_b64_tr_b16 v[70:71], v54 offset:2560
  v_mfma_f32_32x32x16_bf16 a[16:31], v[20:23], a[96:99], a[16:31]
  ds_read_b64_tr_b16 v[72:73], v55 offset:2048
  ds_read_b64_tr_b16 v[74:75], v55 offset:2560
  s_waitcnt vmcnt(6)
  s_waitcnt lgkmcnt(8)
  v_mfma_f32_32x32x16_bf16 a[0:15], v[24:27], a[100:103], a[0:15]
  ds_read_b64_tr_b16 v[16:17], v54 offset:4096
  ds_read_b64_tr_b16 v[18:19], v54 offset:4608
  v_mfma_f32_32x32x16_bf16 a[16:31], v[28:31], a[100:103], a[16:31]
  ds_read_b64_tr_b16 v[20:21], v55 offset:4096
  ds_read_b64_tr_b16 v[22:23], v55 offset:4608
  s_waitcnt vmcnt(5)
  s_waitcnt lgkmcnt(8)
  v_mfma_f32_32x32x16_bf16 a[0:15], v[60:63], a[104:107], a[0:15]
  ds_read_b64_tr_b16 v[24:25], v54 offset:6144
  ds_read_b64_tr_b16 v[26:27], v54 offset:6656
  v_mfma_f32_32x32x16_bf16 a[16:31], v[64:67], a[104:107], a[16:31]
  ds_read_b64_tr_b16 v[28:29], v55 offset:6144
  ds_read_b64_tr_b16 v[30:31], v55 offset:6656
  s_waitcnt vmcnt(4)
  s_waitcnt lgkmcnt(8)
  v_mfma_f32_32x32x16_bf16 a[0:15], v[68:71], a[108:111], a[0:15]
  ds_read_b64_tr_b16 v[60:61], v54 offset:8192
  ds_read_b64_tr_b16 v[62:63], v54 offset:8704
  v_mfma_f32_32x32x16_bf16 a[16:31], v[72:75], a[108:111], a[16:31]
  ds_read_b64_tr_b16 v[64:65], v55 offset:8192
  ds_read_b64_tr_b16 v[66:67], v55 offset:8704
  s_waitcnt vmcnt(3)
  s_waitcnt lgkmcnt(8)
  v_mfma_f32_32x32x16_bf16 a[0:15], v[16:19], a[112:115], a[0:15]
  ds_read_b64_tr_b16 v[68:69], v54 offset:10240
  ds_read_b64_tr_b16 v[70:71], v54 offset:10752
  v_mfma_f32_32x32x16_bf16 a[16:31], v[20:23], a[112:115], a[16:31]
  ds_read_b64_tr_b16 v[72:73], v55 offset:10240
  ds_read_b64_tr_b16 v[74:75], v55 offset:10752
  s_waitcnt vmcnt(2)
  s_waitcnt lgkmcnt(8)
  v_mfma_f32_32x32x16_bf16 a[0:15], v[24:27], a[116:119], a[0:15]
  v_mfma_f32_32x32x16_bf16 a[16:31], v[28:31], a[116:119], a[16:31]
  s_waitcnt vmcnt(1)
  s_waitcnt lgkmcnt(4)
  v_mfma_f32_32x32x16_bf16 a[0:15], v[60:63], a[120:123], a[0:15]
  v_mfma_f32_32x32x16_bf16 a[16:31], v[64:67], a[120:123], a[16:31]
  s_waitcnt vmcnt(0)
  s_waitcnt lgkmcnt(0)
  v_mfma_f32_32x32x16_bf16 a[0:15], v[68:71], a[124:127], a[0:15]
  v_mfma_f32_32x32x16_bf16 a[16:31], v[72:75], a[124:127], a[16:31]
  s_lshl_b32 s3, s46, 13
  v_add_u32 v58, s3, v35
  s_nop 8
  ds_write_b128 v58, a[0:3] offset:0
  ds_write_b128 v58, a[4:7] offset:1024
  ds_write_b128 v58, a[8:11] offset:2048
  ds_write_b128 v58, a[12:15] offset:3072
  ds_write_b128 v58, a[16:19] offset:4096
  ds_write_b128 v58, a[20:23] offset:5120
  ds_write_b128 v58, a[24:27] offset:6144
  ds_write_b128 v58, a[28:31] offset:7168
  s_waitcnt lgkmcnt(0)
  s_barrier
  s_branch L_end
L_helper:
  s_mov_b32 s51, 0
  v_mov_b32 v6, 0
  buffer_load_dword v14, v6, s[40:43], 0 offen sc1
  s_waitcnt vmcnt(13) lgkmcnt(0)
  s_barrier
  s_waitcnt vmcnt(8)
  s_barrier
  s_add_u32 s90, s59, 4
  s_and_b32 s90, s90, 7
  s_add_u32 m0, s60, 143360
  s_lshl_b32 s63, s90, 7
  buffer_load_dwordx4 v10, s[12:15], s63 offen lds
  s_mul_i32 s90, s90, 176128
  s_add_u32 m0, s61, 131072
  s_add_u32 s63, s56, s90
  buffer_load_dwordx4 v11, s[8:11], s63 offen lds
  s_add_u32 m0, m0, 1024
  s_nop 0
  buffer_load_dwordx4 v12, s[8:11], s63 offen lds
  s_add_u32 m0, m0, 1024
  s_nop 0
  buffer_load_dwordx4 v13, s[8:11], s63 offen lds
  s_waitcnt vmcnt(8)
  s_barrier
  s_add_u32 s90, s59, 5
  s_and_b32 s90, s90, 7
  s_add_u32 m0, s60, 77824
  s_lshl_b32 s63, s90, 7
  buffer_load_dwordx4 v10, s[12:15], s63 offen lds
  s_mul_i32 s90, s90, 176128
  s_add_u32 m0, s61, 65536
  s_add_u32 s63, s56, s90
  buffer_load_dwordx4 v11, s[8:11], s63 offen lds
  s_add_u32 m0, m0, 1024
  s_nop 0
  buffer_load_dwordx4 v12, s[8:11], s63 offen lds
  s_add_u32 m0, m0, 1024
  s_nop 0
  buffer_load_dwordx4 v13, s[8:11], s63 offen lds
  s_waitcnt vmcnt(8)
  s_barrier
  s_add_u32 s90, s59, 6
  s_and_b32 s90, s90, 7
  s_add_u32 m0, s60, 94208
  s_lshl_b32 s63, s90, 7
  buffer_load_dwordx4 v10, s[12:15], s63 offen lds
  s_mul_i32 s90, s90, 176128
  s_add_u32 m0, s61, 81920
  s_add_u32 s63, s56, s90
  buffer_load_dwordx4 v11, s[8:11], s63 offen lds
  s_add_u32 m0, m0, 1024
  s_nop 0
  buffer_load_dwordx4 v12, s[8:11], s63 offen lds
  s_add_u32 m0, m0, 1024
  s_nop 0
  buffer_load_dwordx4 v13, s[8:11], s63 offen lds
  s_waitcnt vmcnt(8)
  s_barrier
  s_add_u32 s90, s59, 7
  s_and_b32 s90, s90, 7
  s_add_u32 m0, s60, 110592
  s_lshl_b32 s63, s90, 7
  buffer_load_dwordx4 v10, s[12:15], s63 offen lds
  s_mul_i32 s90, s90, 176128
  s_add_u32 m0, s61, 98304
  s_add_u32 s63, s56, s90
  buffer_load_dwordx4 v11, s[8:11], s63 offen lds
  s_add_u32 m0, m0, 1024
  s_nop 0
  buffer_load_dwordx4 v12, s[8:11], s63 offen lds
  s_add_u32 m0, m0, 1024
  s_nop 0
  buffer_load_dwordx4 v13, s[8:11], s63 offen lds
  s_waitcnt vmcnt(8)
  s_barrier
  s_add_u32 s90, s59, 0
  s_and_b32 s90, s90, 7
  s_add_u32 m0, s60, 126976
  s_lshl_b32 s63, s90, 7
  buffer_load_dwordx4 v10, s[16:19], s63 offen lds
  s_mul_i32 s90, s90, 176128
  s_add_u32 m0, s61, 114688
  s_add_u32 s63, s62, s90
  buffer_load_dwordx4 v11, s[8:11], s63 offen lds
  s_add_u32 m0, m0, 1024
  s_nop 0
  buffer_load_dwordx4 v12, s[8:11], s63 offen lds
  s_add_u32 m0, m0, 1024
  s_nop 0
  buffer_load_dwordx4 v13, s[8:11], s63 offen lds
  s_waitcnt vmcnt(8)
  s_barrier
  s_add_u32 s90, s59, 1
  s_and_b32 s90, s90, 7
  s_add_u32 m0, s60, 143360
  s_lshl_b32 s63, s90, 7
  buffer_load_dwordx4 v10, s[16:19], s63 offen lds
  s_mul_i32 s90, s90, 176128
  s_add_u32 m0, s61, 131072
  s_add_u32 s63, s62, s90
  buffer_load_dwordx4 v11, s[8:11], s63 offen lds
  s_add_u32 m0, m0, 1024
  s_nop 0
  buffer_load_dwordx4 v12, s[8:11], s63 offen lds
  s_add_u32 m0, m0, 1024
  s_nop 0
  buffer_load_dwordx4 v13, s[8:11], s63 offen lds
  s_waitcnt vmcnt(8)
  s_barrier
  s_add_u32 s90, s59, 2
  s_and_b32 s90, s90, 7
  s_add_u32 m0, s60, 77824
  s_lshl_b32 s63, s90, 7
  buffer_load_dwordx4 v10, s[16:19], s63 offen lds
  s_mul_i32 s90, s90, 176128
  s_add_u32 m0, s61, 65536
  s_add_u32 s63, s62, s90
  buffer_load_dwordx4 v11, s[8:11], s63 offen lds
  s_add_u32 m0, m0, 1024
  s_nop 0
  buffer_load_dwordx4 v12, s[8:11], s63 offen lds
  s_add_u32 m0, m0, 1024
  s_nop 0
  buffer_load_dwordx4 v13, s[8:11], s63 offen lds
  s_waitcnt vmcnt(8)
  s_barrier
  s_add_u32 s90, s59, 3
  s_and_b32 s90, s90, 7
  s_add_u32 m0, s60, 94208
  s_lshl_b32 s63, s90, 7
  buffer_load_dwordx4 v10, s[16:19], s63 offen lds
  s_mul_i32 s90, s90, 176128
  s_add_u32 m0, s61, 81920
  s_add_u32 s63, s62, s90
  buffer_load_dwordx4 v11, s[8:11], s63 offen lds
  s_add_u32 m0, m0, 1024
  s_nop 0
  buffer_load_dwordx4 v12, s[8:11], s63 offen lds
  s_add_u32 m0, m0, 1024
  s_nop 0
  buffer_load_dwordx4 v13, s[8:11], s63 offen lds
  v_readfirstlane_b32 s49, v14
  s_nop 0
  s_cmp_lg_u32 s49, 0
  s_cbranch_scc1 L_hn_14
  v_mov_b32 v6, 0
  s_mov_b32 s98, 0
L_nonce_15:
  buffer_load_dword v5, v6, s[40:43], 0 offen sc1
  s_waitcnt vmcnt(0)
  v_readfirstlane_b32 s49, v5
  s_add_u32 s98, s98, 1
  s_cmp_gt_u32 s98, 0x8000
  s_cbranch_scc1 L_nonce_15_x
  s_cmp_eq_u32 s49, 0
  s_cbranch_scc1 L_nonce_15
L_nonce_15_x:
L_hn_14:
  s_barrier
  s_cmp_lg_u32 s58, 0
  s_cbranch_scc1 L_h_nopub
  v_lshlrev_b32 v8, 3, v2
  v_add_u32 v8, 147456, v8
  ds_read_b64 v[16:17], v8 offset:0
  ds_read_b64 v[18:19], v8 offset:256
  ds_read_b64 v[20:21], v8 offset:512
  ds_read_b64 v[22:23], v8 offset:768
  ds_read_b64 v[24:25], v8 offset:1024
  ds_read_b64 v[26:27], v8 offset:1280
  s_waitcnt lgkmcnt(0)
  v_pk_add_f32 v[16:17], v[16:17], v[20:21]
  v_pk_add_f32 v[18:19], v[18:19], v[22:23]
  v_pk_add_f32 v[16:17], v[16:17], v[24:25]
  v_pk_add_f32 v[18:19], v[18:19], v[26:27]
  v_mov_b32 v32, v16
  v_mov_b32 v33, s49
  v_mov_b32 v34, v17
  v_mov_b32 v35, s49
  v_mov_b32 v36, v18
  v_mov_b32 v37, s49
  v_mov_b32 v38, v19
  v_mov_b32 v39, s49
  s_lshl_b32 s63, s44, 3
  s_add_u32 s63, s63, s45
  s_lshl_b32 s63, s63, 10
  s_add_u32 s63, s63, 0x20000
  v_lshlrev_b32 v8, 4, v2
  s_mov_b32 exec_hi, 0
  buffer_store_dwordx4 v[32:35], v8, s[28:31], s63 offen sc1
  buffer_store_dwordx4 v[36:39], v8, s[28:31], s63 offen offset:512 sc1
  s_mov_b64 exec, -1
L_h_nopub:
  s_waitcnt vmcnt(8)
  s_barrier
  s_add_u32 s90, s59, 4
  s_and_b32 s90, s90, 7
  s_add_u32 m0, s60, 110592
  s_lshl_b32 s63, s90, 7
  buffer_load_dwordx4 v10, s[16:19], s63 offen lds
  s_mul_i32 s90, s90, 176128
  s_add_u32 m0, s61, 98304
  s_add_u32 s63, s62, s90
  buffer_load_dwordx4 v11, s[8:11], s63 offen lds
  s_add_u32 m0, m0, 1024
  s_nop 0
  buffer_load_dwordx4 v12, s[8:11], s63 offen lds
  s_add_u32 m0, m0, 1024
  s_nop 0
  buffer_load_dwordx4 v13, s[8:11], s63 offen lds
  s_cmp_lt_u32 s58, 2
  s_cbranch_scc1 L_role_1016_s
  v_bfe_u32 v16, v2, 2, 1
  v_lshlrev_b32 v16, 4, v16
  v_bfe_u32 v17, v2, 3, 2
  v_lshl_or_b32 v16, v17, 2, v16
  v_and_b32 v17, 3, v2
  v_or_b32 v16, v16, v17
  v_cvt_f32_u32 v46, v16
  v_cvt_f32_u32 v47, v3
  v_mul_f32 v47, 0x41000000, v47
  v_mul_f32 v18, 0x3d000000, v46
  v_mul_f32 v19, v18, v47
  v_mov_b32 v20, v19
  v_fmamk_f32 v21, v18, 0x3f800000, v19
  v_fmamk_f32 v22, v18, 0x40000000, v19
  v_fmamk_f32 v23, v18, 0x40400000, v19
  v_fmamk_f32 v24, v18, 0x40800000, v19
  v_fmamk_f32 v25, v18, 0x40a00000, v19
  v_fmamk_f32 v26, v18, 0x40c00000, v19
  v_fmamk_f32 v27, v18, 0x40e00000, v19
  v_fract_f32 v20, v20
  v_fract_f32 v21, v21
  v_fract_f32 v22, v22
  v_fract_f32 v23, v23
  v_fract_f32 v24, v24
  v_fract_f32 v25, v25
  v_fract_f32 v26, v26
  v_fract_f32 v27, v27
  v_cos_f32 v28, v20
  v_sin_f32 v36, v20
  v_cos_f32 v29, v21
  v_sin_f32 v37, v21
  v_cos_f32 v30, v22
  v_sin_f32 v38, v22
  v_cos_f32 v31, v23
  v_sin_f32 v39, v23
  v_cos_f32 v32, v24
  v_sin_f32 v40, v24
  v_cos_f32 v33, v25
  v_sin_f32 v41, v25
  v_cos_f32 v34, v26
  v_sin_f32 v42, v26
  s_branch L_role_1016_d
L_role_1016_s:
L_role_1016_d:
  s_waitcnt vmcnt(8)
  s_barrier
  s_add_u32 s90, s59, 5
  s_and_b32 s90, s90, 7
  s_add_u32 m0, s60, 126976
  s_lshl_b32 s63, s90, 7
  buffer_load_dwordx4 v10, s[16:19], s63 offen lds
  s_mul_i32 s90, s90, 176128
  s_add_u32 m0, s61, 114688
  s_add_u32 s63, s62, s90
  buffer_load_dwordx4 v11, s[8:11], s63 offen lds
  s_add_u32 m0, m0, 1024
  s_nop 0
  buffer_load_dwordx4 v12, s[8:11], s63 offen lds
  s_add_u32 m0, m0, 1024
  s_nop 0
  buffer_load_dwordx4 v13, s[8:11], s63 offen lds
  s_cmp_lt_u32 s58, 2
  s_cbranch_scc1 L_role_1017_s
  v_cos_f32 v35, v27
  v_sin_f32 v43, v27
  v_cvt_pk_bf16_f32 v20, v28, v29
  v_cvt_pk_bf16_f32 v21, -v36, -v37
  v_cvt_pk_bf16_f32 v22, v36, v37
  v_accvgpr_write_b32 a0, v20
  v_accvgpr_write_b32 a8, v21
  v_accvgpr_write_b32 a16, v22
  v_cvt_pk_bf16_f32 v20, v30, v31
  v_cvt_pk_bf16_f32 v21, -v38, -v39
  v_cvt_pk_bf16_f32 v22, v38, v39
  v_accvgpr_write_b32 a1, v20
  v_accvgpr_write_b32 a9, v21
  v_accvgpr_write_b32 a17, v22
  v_cvt_pk_bf16_f32 v20, v32, v33
  v_cvt_pk_bf16_f32 v21, -v40, -v41
  v_cvt_pk_bf16_f32 v22, v40, v41
  v_accvgpr_write_b32 a2, v20
  v_accvgpr_write_b32 a10, v21
  v_accvgpr_write_b32 a18, v22
  v_cvt_pk_bf16_f32 v20, v34, v35
  v_cvt_pk_bf16_f32 v21, -v42, -v43
  v_cvt_pk_bf16_f32 v22, v42, v43
  v_accvgpr_write_b32 a3, v20
  v_accvgpr_write_b32 a11, v21
  v_accvgpr_write_b32 a19, v22
  v_fmamk_f32 v20, v18, 0x41800000, v19
  v_fmamk_f32 v21, v18, 0x41880000, v19
  v_fmamk_f32 v22, v18, 0x41900000, v19
  v_fmamk_f32 v23, v18, 0x41980000, v19
  v_fmamk_f32 v24, v18, 0x41a00000, v19
  v_fmamk_f32 v25, v18, 0x41a80000, v19
  v_fmamk_f32 v26, v18, 0x41b00000, v19
  v_fmamk_f32 v27, v18, 0x41b80000, v19
  v_fract_f32 v20, v20
  v_fract_f32 v21, v21
  v_fract_f32 v22, v22
  v_fract_f32 v23, v23
  v_fract_f32 v24, v24
  v_fract_f32 v25, v25
  v_fract_f32 v26, v26
  s_branch L_role_1017_d
L_role_1017_s:
L_role_1017_d:
  s_waitcnt vmcnt(8)
  s_barrier
  s_add_u32 s90, s59, 6
  s_and_b32 s90, s90, 7
  s_add_u32 m0, s60, 143360
  s_lshl_b32 s63, s90, 7
  buffer_load_dwordx4 v10, s[16:19], s63 offen lds
  s_mul_i32 s90, s90, 176128
  s_add_u32 m0, s61, 131072
  s_add_u32 s63, s62, s90
  buffer_load_dwordx4 v11, s[8:11], s63 offen lds
  s_add_u32 m0, m0, 1024
  s_nop 0
  buffer_load_dwordx4 v12, s[8:11], s63 offen lds
  s_add_u32 m0, m0, 1024
  s_nop 0
  buffer_load_dwordx4 v13, s[8:11], s63 offen lds
  s_cmp_lt_u32 s58, 2
  s_cbranch_scc1 L_role_1018_s
  v_fract_f32 v27, v27
  v_cos_f32 v28, v20
  v_sin_f32 v36, v20
  v_cos_f32 v29, v21
  v_sin_f32 v37, v21
  v_cos_f32 v30, v22
  v_sin_f32 v38, v22
  v_cos_f32 v31, v23
  v_sin_f32 v39, v23
  v_cos_f32 v32, v24
  v_sin_f32 v40, v24
  v_cos_f32 v33, v25
  v_sin_f32 v41, v25
  v_cos_f32 v34, v26
  v_sin_f32 v42, v26
  v_cos_f32 v35, v27
  v_sin_f32 v43, v27
  v_cvt_pk_bf16_f32 v20, v28, v29
  v_cvt_pk_bf16_f32 v21, -v36, -v37
  v_cvt_pk_bf16_f32 v22, v36, v37
  v_accvgpr_write_b32 a4, v20
  v_accvgpr_write_b32 a12, v21
  v_accvgpr_write_b32 a20, v22
  v_cvt_pk_bf16_f32 v20, v30, v31
  v_cvt_pk_bf16_f32 v21, -v38, -v39
  v_cvt_pk_bf16_f32 v22, v38, v39
  v_accvgpr_write_b32 a5, v20
  v_accvgpr_write_b32 a13, v21
  v_accvgpr_write_b32 a21, v22
  v_cvt_pk_bf16_f32 v20, v32, v33
  v_cvt_pk_bf16_f32 v21, -v40, -v41
  v_cvt_pk_bf16_f32 v22, v40, v41
  v_accvgpr_write_b32 a6, v20
  v_accvgpr_write_b32 a14, v21
  v_accvgpr_write_b32 a22, v22
  v_cvt_pk_bf16_f32 v20, v34, v35
  v_cvt_pk_bf16_f32 v21, -v42, -v43
  v_cvt_pk_bf16_f32 v22, v42, v43
  v_accvgpr_write_b32 a7, v20
  v_accvgpr_write_b32 a15, v21
  v_accvgpr_write_b32 a23, v22
  s_branch L_role_1018_d
L_role_1018_s:
L_role_1018_d:
  s_waitcnt vmcnt(8)
  s_barrier
  s_add_u32 s90, s59, 7
  s_and_b32 s90, s90, 7
  s_add_u32 m0, s60, 77824
  s_lshl_b32 s63, s90, 7
  buffer_load_dwordx4 v10, s[16:19], s63 offen lds
  s_mul_i32 s90, s90, 176128
  s_add_u32 m0, s61, 65536
  s_add_u32 s63, s62, s90
  buffer_load_dwordx4 v11, s[8:11], s63 offen lds
  s_add_u32 m0, m0, 1024
  s_nop 0
  buffer_load_dwordx4 v12, s[8:11], s63 offen lds
  s_add_u32 m0, m0, 1024
  s_nop 0
  buffer_load_dwordx4 v13, s[8:11], s63 offen lds
  v_lshrrev_b32 v5, 4, v1
  v_and_b32 v6, 15, v1
  v_add_u32 v7, 0, v5
  v_xor_b32 v7, v7, v6
  v_lshlrev_b32 v7, 4, v7
  v_lshl_add_u32 v120, v5, 12, v7
  v_add_u32 v7, 4, v5
  v_xor_b32 v7, v7, v6
  v_lshlrev_b32 v7, 4, v7
  v_lshl_add_u32 v121, v5, 12, v7
  v_add_u32 v7, 8, v5
  v_xor_b32 v7, v7, v6
  v_lshlrev_b32 v7, 4, v7
  v_lshl_add_u32 v122, v5, 12, v7
  v_add_u32 v7, 12, v5
  v_xor_b32 v7, v7, v6
  v_lshlrev_b32 v7, 4, v7
  v_lshl_add_u32 v123, v5, 12, v7
  s_lshl_b32 s90, s44, 18
  s_lshl_b32 s3, s58, 10
  s_add_u32 s90, s90, s3
  s_add_u32 s67, s90, 512
  s_add_u32 s68, s90, 768
  s_add_u32 s69, s90, 2560
  s_cmp_lt_u32 s58, 2
  s_cbranch_scc1 L_role_1019_s
  v_accvgpr_write_b32 a60, v46
  v_accvgpr_write_b32 a61, v47
  s_sub_u32 s3, s58, 2
  s_lshl_b32 s3, s3, 5
  v_add_u32 v18, s3, v2
  v_cvt_f32_u32 v18, v18
  v_mul_f32 v18, 0x3c800000, v18
  v_mul_f32 v19, v18, v47
  v_mov_b32 v20, v19
  v_fmamk_f32 v21, v18, 0x3f800000, v19
  v_fmamk_f32 v22, v18, 0x40000000, v19
  v_fmamk_f32 v23, v18, 0x40400000, v19
  v_fmamk_f32 v24, v18, 0x40800000, v19
  v_fmamk_f32 v25, v18, 0x40a00000, v19
  v_fmamk_f32 v26, v18, 0x40c00000, v19
  v_fmamk_f32 v27, v18, 0x40e00000, v19
  v_fract_f32 v20, v20
  v_fract_f32 v21, v21
  v_fract_f32 v22, v22
  v_fract_f32 v23, v23
  v_fract_f32 v24, v24
  v_fract_f32 v25, v25
  v_fract_f32 v26, v26
  v_fract_f32 v27, v27
  v_cos_f32 v28, v20
  v_sin_f32 v36, v20
  v_cos_f32 v29, v21
  v_sin_f32 v37, v21
  v_cos_f32 v30, v22
  v_sin_f32 v38, v22
  v_cos_f32 v31, v23
  v_sin_f32 v39, v23
  v_cos_f32 v32, v24
  v_sin_f32 v40, v24
  v_cos_f32 v33, v25
  v_sin_f32 v41, v25
  v_cos_f32 v34, v26
  v_sin_f32 v42, v26
  v_cos_f32 v35, v27
  v_sin_f32 v43, v27
  v_cvt_pk_bf16_f32 v20, v28, v29
  s_branch L_role_1019_d
L_role_1019_s:
L_role_1019_d:
  s_cmp_ge_u32 s58, 2
  s_cbranch_scc1 L_hw_1020_b
  s_waitcnt vmcnt(8)
  s_branch L_hw_1020_d
L_hw_1020_b:
  s_cmp_eq_u32 s58, 2
  s_cbranch_scc1 L_hw_1020_c
  s_waitcnt vmcnt(8)
  s_branch L_hw_1020_d
L_hw_1020_c:
  s_waitcnt vmcnt(8)
L_hw_1020_d:
  s_barrier
  s_cmp_lt_u32 s58, 2
  s_cbranch_scc1 L_role_1021_s
  v_cvt_pk_bf16_f32 v21, v36, v37
  v_accvgpr_write_b32 a24, v20
  v_accvgpr_write_b32 a32, v21
  v_cvt_pk_bf16_f32 v20, v30, v31
  v_cvt_pk_bf16_f32 v21, v38, v39
  v_accvgpr_write_b32 a25, v20
  v_accvgpr_write_b32 a33, v21
  v_cvt_pk_bf16_f32 v20, v32, v33
  v_cvt_pk_bf16_f32 v21, v40, v41
  v_accvgpr_write_b32 a26, v20
  v_accvgpr_write_b32 a34, v21
  v_cvt_pk_bf16_f32 v20, v34, v35
  v_cvt_pk_bf16_f32 v21, v42, v43
  v_accvgpr_write_b32 a27, v20
  v_accvgpr_write_b32 a35, v21
  v_fmamk_f32 v20, v18, 0x41800000, v19
  v_fmamk_f32 v21, v18, 0x41880000, v19
  v_fmamk_f32 v22, v18, 0x41900000, v19
  v_fmamk_f32 v23, v18, 0x41980000, v19
  v_fmamk_f32 v24, v18, 0x41a00000, v19
  v_fmamk_f32 v25, v18, 0x41a80000, v19
  v_fmamk_f32 v26, v18, 0x41b00000, v19
  v_fmamk_f32 v27, v18, 0x41b80000, v19
  v_fract_f32 v20, v20
  v_fract_f32 v21, v21
  v_fract_f32 v22, v22
  v_fract_f32 v23, v23
  v_fract_f32 v24, v24
  v_fract_f32 v25, v25
  v_fract_f32 v26, v26
  v_fract_f32 v27, v27
  v_cos_f32 v28, v20
  v_sin_f32 v36, v20
  v_cos_f32 v29, v21
  v_sin_f32 v37, v21
  v_cos_f32 v30, v22
  v_sin_f32 v38, v22
  v_cos_f32 v31, v23
  v_sin_f32 v39, v23
  v_cos_f32 v32, v24
  v_sin_f32 v40, v24
  s_branch L_role_1021_d
L_role_1021_s:
  s_add_u32 s63, s67, 0
  buffer_load_dwordx4 a[0:3], v120, s[20:23], s63 offen
  s_add_u32 s63, s67, 16384
  buffer_load_dwordx4 a[4:7], v121, s[20:23], s63 offen
  s_add_u32 s63, s67, 32768
  buffer_load_dwordx4 a[8:11], v122, s[20:23], s63 offen
  s_add_u32 s63, s67, 49152
  buffer_load_dwordx4 a[12:15], v123, s[20:23], s63 offen
  s_add_u32 s63, s67, 65536
  buffer_load_dwordx4 a[16:19], v120, s[20:23], s63 offen
  s_add_u32 s63, s67, 81920
  buffer_load_dwordx4 a[20:23], v121, s[20:23], s63 offen
  s_add_u32 s63, s67, 98304
  buffer_load_dwordx4 a[24:27], v122, s[20:23], s63 offen
  s_add_u32 s63, s67, 114688
  buffer_load_dwordx4 a[28:31], v123, s[20:23], s63 offen
  s_add_u32 s63, s67, 131072
  buffer_load_dwordx4 a[32:35], v120, s[20:23], s63 offen
  s_add_u32 s63, s67, 147456
  buffer_load_dwordx4 a[36:39], v121, s[20:23], s63 offen
  s_add_u32 s63, s67, 163840
  buffer_load_dwordx4 a[40:43], v122, s[20:23], s63 offen
  s_add_u32 s63, s67, 180224
  buffer_load_dwordx4 a[44:47], v123, s[20:23], s63 offen
L_role_1021_d:
  s_cmp_ge_u32 s58, 2
  s_cbranch_scc1 L_hw_1022_b
  s_waitcnt vmcnt(16)
  s_branch L_hw_1022_d
L_hw_1022_b:
  s_cmp_eq_u32 s58, 2
  s_cbranch_scc1 L_hw_1022_c
  s_waitcnt vmcnt(4)
  s_branch L_hw_1022_d
L_hw_1022_c:
  s_waitcnt vmcnt(4)
L_hw_1022_d:
  s_barrier
  s_cmp_lg_u32 s58, 2
  s_cbranch_scc1 L_si_1023
  s_lshl_b32 s63, s44, 13
  s_add_u32 s63, s63, 0x20000
  v_lshlrev_b32 v8, 4, v2
  buffer_load_dwordx4 v[48:51], v8, s[28:31], s63 offen offset:0 sc1
  buffer_load_dwordx4 v[52:55], v8, s[28:31], s63 offen offset:512 sc1
  s_add_u32 s63, s63, 1024
  buffer_load_dwordx4 v[56:59], v8, s[28:31], s63 offen offset:0 sc1
  buffer_load_dwordx4 v[60:63], v8, s[28:31], s63 offen offset:512 sc1
  s_add_u32 s63, s63, 1024
  buffer_load_dwordx4 v[64:67], v8, s[28:31], s63 offen offset:0 sc1
  buffer_load_dwordx4 v[68:71], v8, s[28:31], s63 offen offset:512 sc1
  s_add_u32 s63, s63, 1024
  buffer_load_dwordx4 v[72:75], v8, s[28:31], s63 offen offset:0 sc1
  buffer_load_dwordx4 v[76:79], v8, s[28:31], s63 offen offset:512 sc1
  s_add_u32 s63, s63, 1024
  buffer_load_dwordx4 v[80:83], v8, s[28:31], s63 offen offset:0 sc1
  buffer_load_dwordx4 v[84:87], v8, s[28:31], s63 offen offset:512 sc1
  s_add_u32 s63, s63, 1024
  buffer_load_dwordx4 v[88:91], v8, s[28:31], s63 offen offset:0 sc1
  buffer_load_dwordx4 v[92:95], v8, s[28:31], s63 offen offset:512 sc1
  s_add_u32 s63, s63, 1024
  buffer_load_dwordx4 v[96:99], v8, s[28:31], s63 offen offset:0 sc1
  buffer_load_dwordx4 v[100:103], v8, s[28:31], s63 offen offset:512 sc1
  s_add_u32 s63, s63, 1024
  buffer_load_dwordx4 v[104:107], v8, s[28:31], s63 offen offset:0 sc1
  buffer_load_dwordx4 v[108:111], v8, s[28:31], s63 offen offset:512 sc1
L_si_1023:
  s_cmp_lt_u32 s58, 2
  s_cbranch_scc1 L_role_1024_s
  v_cos_f32 v33, v25
  v_sin_f32 v41, v25
  v_cos_f32 v34, v26
  v_sin_f32 v42, v26
  v_cos_f32 v35, v27
  v_sin_f32 v43, v27
  v_cvt_pk_bf16_f32 v20, v28, v29
  v_cvt_pk_bf16_f32 v21, v36, v37
  v_accvgpr_write_b32 a28, v20
  v_accvgpr_write_b32 a36, v21
  v_cvt_pk_bf16_f32 v20, v30, v31
  v_cvt_pk_bf16_f32 v21, v38, v39
  v_accvgpr_write_b32 a29, v20
  v_accvgpr_write_b32 a37, v21
  v_cvt_pk_bf16_f32 v20, v32, v33
  v_cvt_pk_bf16_f32 v21, v40, v41
  v_accvgpr_write_b32 a30, v20
  v_accvgpr_write_b32 a38, v21
  v_cvt_pk_bf16_f32 v20, v34, v35
  v_cvt_pk_bf16_f32 v21, v42, v43
  v_accvgpr_write_b32 a31, v20
  v_accvgpr_write_b32 a39, v21
  v_fmamk_f32 v20, v18, 0x42000000, v19
  v_fmamk_f32 v21, v18, 0x42040000, v19
  v_fmamk_f32 v22, v18, 0x42080000, v19
  v_fmamk_f32 v23, v18, 0x420c0000, v19
  v_fmamk_f32 v24, v18, 0x42100000, v19
  v_fmamk_f32 v25, v18, 0x42140000, v19
  v_fmamk_f32 v26, v18, 0x42180000, v19
  v_fmamk_f32 v27, v18, 0x421c0000, v19
  v_fract_f32 v20, v20
  v_fract_f32 v21, v21
  v_fract_f32 v22, v22
  v_fract_f32 v23, v23
  v_fract_f32 v24, v24
  v_fract_f32 v25, v25
  v_fract_f32 v26, v26
  v_fract_f32 v27, v27
  v_cos_f32 v28, v20
  v_sin_f32 v36, v20
  v_cos_f32 v29, v21
  s_branch L_role_1024_d
L_role_1024_s:
  s_add_u32 s63, s67, 196608
  buffer_load_dwordx4 a[48:51], v120, s[20:23], s63 offen
  s_add_u32 s63, s67, 212992
  buffer_load_dwordx4 a[52:55], v121, s[20:23], s63 offen
  s_add_u32 s63, s67, 229376
  buffer_load_dwordx4 a[56:59], v122, s[20:23], s63 offen
  s_add_u32 s63, s67, 245760
  buffer_load_dwordx4 a[60:63], v123, s[20:23], s63 offen
  s_add_u32 s63, s68, 0
  buffer_load_dwordx4 a[64:67], v120, s[20:23], s63 offen
  s_add_u32 s63, s68, 16384
  buffer_load_dwordx4 a[68:71], v121, s[20:23], s63 offen
  s_add_u32 s63, s68, 32768
  buffer_load_dwordx4 a[72:75], v122, s[20:23], s63 offen
  s_add_u32 s63, s68, 49152
  buffer_load_dwordx4 a[76:79], v123, s[20:23], s63 offen
  s_add_u32 s63, s68, 65536
  buffer_load_dwordx4 a[80:83], v120, s[20:23], s63 offen
  s_add_u32 s63, s68, 81920
  buffer_load_dwordx4 a[84:87], v121, s[20:23], s63 offen
  s_add_u32 s63, s68, 98304
  buffer_load_dwordx4 a[88:91], v122, s[20:23], s63 offen
  s_add_u32 s63, s68, 114688
  buffer_load_dwordx4 a[92:95], v123, s[20:23], s63 offen
L_role_1024_d:
  s_cmp_ge_u32 s58, 2
  s_cbranch_scc1 L_hw_1025_b
  s_waitcnt vmcnt(24)
  s_branch L_hw_1025_d
L_hw_1025_b:
  s_cmp_eq_u32 s58, 2
  s_cbranch_scc1 L_hw_1025_c
  s_waitcnt vmcnt(0)
  s_branch L_hw_1025_d
L_hw_1025_c:
  s_waitcnt vmcnt(16)
L_hw_1025_d:
  s_barrier
  s_cmp_lt_u32 s58, 2
  s_cbranch_scc1 L_role_1026_s
  v_sin_f32 v37, v21
  v_cos_f32 v30, v22
  v_sin_f32 v38, v22
  v_cos_f32 v31, v23
  v_sin_f32 v39, v23
  v_cos_f32 v32, v24
  v_sin_f32 v40, v24
  v_cos_f32 v33, v25
  v_sin_f32 v41, v25
  v_cos_f32 v34, v26
  v_sin_f32 v42, v26
  v_cos_f32 v35, v27
  v_sin_f32 v43, v27
  v_cvt_pk_bf16_f32 v20, v28, v29
  v_cvt_pk_bf16_f32 v21, v36, v37
  v_accvgpr_write_b32 a40, v20
  v_accvgpr_write_b32 a48, v21
  v_cvt_pk_bf16_f32 v20, v30, v31
  v_cvt_pk_bf16_f32 v21, v38, v39
  v_accvgpr_write_b32 a41, v20
  v_accvgpr_write_b32 a49, v21
  v_cvt_pk_bf16_f32 v20, v32, v33
  v_cvt_pk_bf16_f32 v21, v40, v41
  v_accvgpr_write_b32 a42, v20
  v_accvgpr_write_b32 a50, v21
  v_cvt_pk_bf16_f32 v20, v34, v35
  v_cvt_pk_bf16_f32 v21, v42, v43
  v_accvgpr_write_b32 a43, v20
  v_accvgpr_write_b32 a51, v21
  v_fmamk_f32 v20, v18, 0x42400000, v19
  v_fmamk_f32 v21, v18, 0x42440000, v19
  v_fmamk_f32 v22, v18, 0x42480000, v19
  v_fmamk_f32 v23, v18, 0x424c0000, v19
  v_fmamk_f32 v24, v18, 0x42500000, v19
  v_fmamk_f32 v25, v18, 0x42540000, v19
  v_fmamk_f32 v26, v18, 0x42580000, v19
  v_fmamk_f32 v27, v18, 0x425c0000, v19
  v_fract_f32 v20, v20
  v_fract_f32 v21, v21
  v_fract_f32 v22, v22
  v_fract_f32 v23, v23
  s_branch L_role_1026_d
L_role_1026_s:
  s_add_u32 s63, s68, 131072
  buffer_load_dwordx4 a[96:99], v120, s[20:23], s63 offen
  s_add_u32 s63, s68, 147456
  buffer_load_dwordx4 a[100:103], v121, s[20:23], s63 offen
  s_add_u32 s63, s68, 163840
  buffer_load_dwordx4 a[104:107], v122, s[20:23], s63 offen
  s_add_u32 s63, s68, 180224
  buffer_load_dwordx4 a[108:111], v123, s[20:23], s63 offen
  s_add_u32 s63, s68, 196608
  buffer_load_dwordx4 a[112:115], v120, s[20:23], s63 offen
  s_add_u32 s63, s68, 212992
  buffer_load_dwordx4 a[116:119], v121, s[20:23], s63 offen
  s_add_u32 s63, s68, 229376
  buffer_load_dwordx4 a[120:123], v122, s[20:23], s63 offen
  s_add_u32 s63, s68, 245760
  buffer_load_dwordx4 a[124:127], v123, s[20:23], s63 offen
  s_add_u32 s63, s69, 0
  buffer_load_dwordx4 v[32:35], v120, s[20:23], s63 offen
  s_add_u32 s63, s69, 16384
  buffer_load_dwordx4 v[36:39], v121, s[20:23], s63 offen
  s_add_u32 s63, s69, 32768
  buffer_load_dwordx4 v[40:43], v122, s[20:23], s63 offen
  s_add_u32 s63, s69, 49152
  buffer_load_dwordx4 v[44:47], v123, s[20:23], s63 offen
L_role_1026_d:
  s_barrier
  s_cmp_lg_u32 s58, 2
  s_cbranch_scc1 L_si_1027
  s_mov_b32 s98, 0
L_sc_1028:
  s_waitcnt vmcnt(0)
  s_mov_b64 s[94:95], 0
  v_cmp_ne_u32 vcc, s49, v49
  s_nop 0
  s_or_b64 s[94:95], s[94:95], vcc
  v_cmp_ne_u32 vcc, s49, v51
  s_nop 0
  s_or_b64 s[94:95], s[94:95], vcc
  v_cmp_ne_u32 vcc, s49, v53
  s_nop 0
  s_or_b64 s[94:95], s[94:95], vcc
  v_cmp_ne_u32 vcc, s49, v55
  s_nop 0
  s_or_b64 s[94:95], s[94:95], vcc
  v_cmp_ne_u32 vcc, s49, v57
  s_nop 0
  s_or_b64 s[94:95], s[94:95], vcc
  v_cmp_ne_u32 vcc, s49, v59
  s_nop 0
  s_or_b64 s[94:95], s[94:95], vcc
  v_cmp_ne_u32 vcc, s49, v61
  s_nop 0
  s_or_b64 s[94:95], s[94:95], vcc
  v_cmp_ne_u32 vcc, s49, v63
  s_nop 0
  s_or_b64 s[94:95], s[94:95], vcc
  v_cmp_ne_u32 vcc, s49, v65
  s_nop 0
  s_or_b64 s[94:95], s[94:95], vcc
  v_cmp_ne_u32 vcc, s49, v67
  s_nop 0
  s_or_b64 s[94:95], s[94:95], vcc
  v_cmp_ne_u32 vcc, s49, v69
  s_nop 0
  s_or_b64 s[94:95], s[94:95], vcc
  v_cmp_ne_u32 vcc, s49, v71
  s_nop 0
  s_or_b64 s[94:95], s[94:95], vcc
  v_cmp_ne_u32 vcc, s49, v73
  s_nop 0
  s_or_b64 s[94:95], s[94:95], vcc
  v_cmp_ne_u32 vcc, s49, v75
  s_nop 0
  s_or_b64 s[94:95], s[94:95], vcc
  v_cmp_ne_u32 vcc, s49, v77
  s_nop 0
  s_or_b64 s[94:95], s[94:95], vcc
  v_cmp_ne_u32 vcc, s49, v79
  s_nop 0
  s_or_b64 s[94:95], s[94:95], vcc
  v_cmp_ne_u32 vcc, s49, v81
  s_nop 0
  s_or_b64 s[94:95], s[94:95], vcc
  v_cmp_ne_u32 vcc, s49, v83
  s_nop 0
  s_or_b64 s[94:95], s[94:95], vcc
  v_cmp_ne_u32 vcc, s49, v85
  s_nop 0
  s_or_b64 s[94:95], s[94:95], vcc
  v_cmp_ne_u32 vcc, s49, v87
  s_nop 0
  s_or_b64 s[94:95], s[94:95], vcc
  v_cmp_ne_u32 vcc, s49, v89
  s_nop 0
  s_or_b64 s[94:95], s[94:95], vcc
  v_cmp_ne_u32 vcc, s49, v91
  s_nop 0
  s_or_b64 s[94:95], s[94:95], vcc
  v_cmp_ne_u32 vcc, s49, v93
  s_nop 0
  s_or_b64 s[94:95], s[94:95], vcc
  v_cmp_ne_u32 vcc, s49, v95
  s_nop 0
  s_or_b64 s[94:95], s[94:95], vcc
  v_cmp_ne_u32 vcc, s49, v97
  s_nop 0
  s_or_b64 s[94:95], s[94:95], vcc
  v_cmp_ne_u32 vcc, s49, v99
  s_nop 0
  s_or_b64 s[94:95], s[94:95], vcc
  v_cmp_ne_u32 vcc, s49, v101
  s_nop 0
  s_or_b64 s[94:95], s[94:95], vcc
  v_cmp_ne_u32 vcc, s49, v103
  s_nop 0
  s_or_b64 s[94:95], s[94:95], vcc
  v_cmp_ne_u32 vcc, s49, v105
  s_nop 0
  s_or_b64 s[94:95], s[94:95], vcc
  v_cmp_ne_u32 vcc, s49, v107
  s_nop 0
  s_or_b64 s[94:95], s[94:95], vcc
  v_cmp_ne_u32 vcc, s49, v109
  s_nop 0
  s_or_b64 s[94:95], s[94:95], vcc
  v_cmp_ne_u32 vcc, s49, v111
  s_nop 0
  s_or_b64 s[94:95], s[94:95], vcc
  s_cmp_eq_u64 s[94:95], 0
  s_cbranch_scc1 L_sc_1028_ok
  s_add_u32 s98, s98, 1
  s_cmp_gt_u32 s98, 0x8000
  s_cbranch_scc1 L_sc_1028_ok
  s_lshl_b32 s63, s44, 13
  s_add_u32 s63, s63, 0x20000
  v_lshlrev_b32 v8, 4, v2
  buffer_load_dwordx4 v[48:51], v8, s[28:31], s63 offen offset:0 sc1
  buffer_load_dwordx4 v[52:55], v8, s[28:31], s63 offen offset:512 sc1
  s_add_u32 s63, s63, 1024
  buffer_load_dwordx4 v[56:59], v8, s[28:31], s63 offen offset:0 sc1
  buffer_load_dwordx4 v[60:63], v8, s[28:31], s63 offen offset:512 sc1
  s_add_u32 s63, s63, 1024
  buffer_load_dwordx4 v[64:67], v8, s[28:31], s63 offen offset:0 sc1
  buffer_load_dwordx4 v[68:71], v8, s[28:31], s63 offen offset:512 sc1
  s_add_u32 s63, s63, 1024
  buffer_load_dwordx4 v[72:75], v8, s[28:31], s63 offen offset:0 sc1
  buffer_load_dwordx4 v[76:79], v8, s[28:31], s63 offen offset:512 sc1
  s_add_u32 s63, s63, 1024
  buffer_load_dwordx4 v[80:83], v8, s[28:31], s63 offen offset:0 sc1
  buffer_load_dwordx4 v[84:87], v8, s[28:31], s63 offen offset:512 sc1
  s_add_u32 s63, s63, 1024
  buffer_load_dwordx4 v[88:91], v8, s[28:31], s63 offen offset:0 sc1
  buffer_load_dwordx4 v[92:95], v8, s[28:31], s63 offen offset:512 sc1
  s_add_u32 s63, s63, 1024
  buffer_load_dwordx4 v[96:99], v8, s[28:31], s63 offen offset:0 sc1
  buffer_load_dwordx4 v[100:103], v8, s[28:31], s63 offen offset:512 sc1
  s_add_u32 s63, s63, 1024
  buffer_load_dwordx4 v[104:107], v8, s[28:31], s63 offen offset:0 sc1
  buffer_load_dwordx4 v[108:111], v8, s[28:31], s63 offen offset:512 sc1
  s_branch L_sc_1028
L_sc_1028_ok:
  v_add_f32 v48, v48, v56
  v_add_f32 v50, v50, v58
  v_add_f32 v48, v48, v64
  v_add_f32 v50, v50, v66
  v_add_f32 v48, v48, v72
  v_add_f32 v50, v50, v74
  v_add_f32 v48, v48, v80
  v_add_f32 v50, v50, v82
  v_add_f32 v48, v48, v88
  v_add_f32 v50, v50, v90
  v_add_f32 v48, v48, v96
  v_add_f32 v50, v50, v98
  v_add_f32 v48, v48, v104
  v_add_f32 v50, v50, v106
  v_add_f32 v52, v52, v60
  v_add_f32 v54, v54, v62
  v_add_f32 v52, v52, v68
  v_add_f32 v54, v54, v70
  v_add_f32 v52, v52, v76
  v_add_f32 v54, v54, v78
  v_add_f32 v52, v52, v84
  v_add_f32 v54, v54, v86
  v_add_f32 v52, v52, v92
  v_add_f32 v54, v54, v94
  v_add_f32 v52, v52, v100
  v_add_f32 v54, v54, v102
  v_add_f32 v52, v52, v108
  v_add_f32 v54, v54, v110
  v_mul_f32 v116, 0x3abe82fa, v48
  v_mul_f32 v117, 0x3abe82fa, v50
  v_fma_f32 v117, -v116, v116, v117
  v_max_f32 v117, 0, v117
  v_add_f32 v117, 0x3727c5ac, v117
  v_rsq_f32 v112, v117
  s_nop 0
  v_mul_f32 v113, v116, v112
  v_sub_f32 v113, 0, v113
  v_mul_f32 v116, 0x3abe82fa, v52
  v_mul_f32 v117, 0x3abe82fa, v54
  v_fma_f32 v117, -v116, v116, v117
  v_max_f32 v117, 0, v117
  v_add_f32 v117, 0x3727c5ac, v117
  v_rsq_f32 v114, v117
  s_nop 0
  v_mul_f32 v115, v116, v114
  v_sub_f32 v115, 0, v115
  v_lshlrev_b32 v8, 3, v2
  v_add_u32 v8, 148992, v8
  ds_write_b64 v8, v[112:113]
  ds_write_b64 v8, v[114:115] offset:256
  s_waitcnt lgkmcnt(0)
L_si_1027:
  s_cmp_lt_u32 s58, 2
  s_cbranch_scc1 L_role_1029_s
  v_fract_f32 v24, v24
  v_fract_f32 v25, v25
  v_fract_f32 v26, v26
  v_fract_f32 v27, v27
  v_cos_f32 v28, v20
  v_sin_f32 v36, v20
  v_cos_f32 v29, v21
  v_sin_f32 v37, v21
  v_cos_f32 v30, v22
  v_sin_f32 v38, v22
  v_cos_f32 v31, v23
  v_sin_f32 v39, v23
  v_cos_f32 v32, v24
  v_sin_f32 v40, v24
  v_cos_f32 v33, v25
  v_sin_f32 v41, v25
  v_cos_f32 v34, v26
  v_sin_f32 v42, v26
  v_cos_f32 v35, v27
  v_sin_f32 v43, v27
  v_cvt_pk_bf16_f32 v20, v28, v29
  v_cvt_pk_bf16_f32 v21, v36, v37
  v_accvgpr_write_b32 a44, v20
  v_accvgpr_write_b32 a52, v21
  v_cvt_pk_bf16_f32 v20, v30, v31
  v_cvt_pk_bf16_f32 v21, v38, v39
  v_accvgpr_write_b32 a45, v20
  v_accvgpr_write_b32 a53, v21
  v_cvt_pk_bf16_f32 v20, v32, v33
  v_cvt_pk_bf16_f32 v21, v40, v41
  v_accvgpr_write_b32 a46, v20
  v_accvgpr_write_b32 a54, v21
  v_cvt_pk_bf16_f32 v20, v34, v35
  v_cvt_pk_bf16_f32 v21, v42, v43
  v_accvgpr_write_b32 a47, v20
  v_accvgpr_write_b32 a55, v21
  s_branch L_role_1029_d
L_role_1029_s:
  s_add_u32 s63, s69, 65536
  buffer_load_dwordx4 v[48:51], v120, s[20:23], s63 offen
  s_add_u32 s63, s69, 81920
  buffer_load_dwordx4 v[52:55], v121, s[20:23], s63 offen
  s_add_u32 s63, s69, 98304
  buffer_load_dwordx4 v[56:59], v122, s[20:23], s63 offen
  s_add_u32 s63, s69, 114688
  buffer_load_dwordx4 v[60:63], v123, s[20:23], s63 offen
  s_add_u32 s63, s69, 131072
  buffer_load_dwordx4 v[64:67], v120, s[20:23], s63 offen
  s_add_u32 s63, s69, 147456
  buffer_load_dwordx4 v[68:71], v121, s[20:23], s63 offen
  s_add_u32 s63, s69, 163840
  buffer_load_dwordx4 v[72:75], v122, s[20:23], s63 offen
  s_add_u32 s63, s69, 180224
  buffer_load_dwordx4 v[76:79], v123, s[20:23], s63 offen
  s_add_u32 s63, s69, 196608
  buffer_load_dwordx4 v[80:83], v120, s[20:23], s63 offen
  s_add_u32 s63, s69, 212992
  buffer_load_dwordx4 v[84:87], v121, s[20:23], s63 offen
  s_add_u32 s63, s69, 229376
  buffer_load_dwordx4 v[88:91], v122, s[20:23], s63 offen
  s_add_u32 s63, s69, 245760
  buffer_load_dwordx4 v[92:95], v123, s[20:23], s63 offen
L_role_1029_d:
  s_barrier
  s_barrier
  v_lshrrev_b32 v5, 4, v1
  v_and_b32 v6, 15, v1
  v_add_u32 v7, 0, v5
  v_xor_b32 v7, v7, v6
  v_lshlrev_b32 v7, 4, v7
  v_lshl_add_u32 v16, v5, 12, v7
  v_add_u32 v7, 4, v5
  v_xor_b32 v7, v7, v6
  v_lshlrev_b32 v7, 4, v7
  v_lshl_add_u32 v17, v5, 12, v7
  v_add_u32 v7, 8, v5
  v_xor_b32 v7, v7, v6
  v_lshlrev_b32 v7, 4, v7
  v_lshl_add_u32 v18, v5, 12, v7
  v_add_u32 v7, 12, v5
  v_xor_b32 v7, v7, v6
  v_lshlrev_b32 v7, 4, v7
  v_lshl_add_u32 v19, v5, 12, v7
  s_lshl_b32 s99, s44, 18
  s_lshl_b32 s3, s58, 10
  s_add_u32 s99, s99, s3
  s_mov_b32 s70, s99
  s_add_u32 s71, s99, 256
  s_lshl_b32 s92, s58, 15
  s_add_u32 s63, s70, 0
  s_add_u32 m0, s92, 0
  s_nop 0
  buffer_load_dwordx4 v16, s[20:23], s63 offen lds
  s_add_u32 s63, s70, 16384
  s_add_u32 m0, s92, 1024
  s_nop 0
  buffer_load_dwordx4 v17, s[20:23], s63 offen lds
  s_add_u32 s63, s70, 32768
  s_add_u32 m0, s92, 2048
  s_nop 0
  buffer_load_dwordx4 v18, s[20:23], s63 offen lds
  s_add_u32 s63, s70, 49152
  s_add_u32 m0, s92, 3072
  s_nop 0
  buffer_load_dwordx4 v19, s[20:23], s63 offen lds
  s_add_u32 s63, s70, 65536
  s_add_u32 m0, s92, 4096
  s_nop 0
  buffer_load_dwordx4 v16, s[20:23], s63 offen lds
  s_add_u32 s63, s70, 81920
  s_add_u32 m0, s92, 5120
  s_nop 0
  buffer_load_dwordx4 v17, s[20:23], s63 offen lds
  s_add_u32 s63, s70, 98304
  s_add_u32 m0, s92, 6144
  s_nop 0
  buffer_load_dwordx4 v18, s[20:23], s63 offen lds
  s_add_u32 s63, s70, 114688
  s_add_u32 m0, s92, 7168
  s_nop 0
  buffer_load_dwordx4 v19, s[20:23], s63 offen lds
  s_add_u32 s63, s70, 131072
  s_add_u32 m0, s92, 8192
  s_nop 0
  buffer_load_dwordx4 v16, s[20:23], s63 offen lds
  s_add_u32 s63, s70, 147456
  s_add_u32 m0, s92, 9216
  s_nop 0
  buffer_load_dwordx4 v17, s[20:23], s63 offen lds
  s_add_u32 s63, s70, 163840
  s_add_u32 m0, s92, 10240
  s_nop 0
  buffer_load_dwordx4 v18, s[20:23], s63 offen lds
  s_add_u32 s63, s70, 180224
  s_add_u32 m0, s92, 11264
  s_nop 0
  buffer_load_dwordx4 v19, s[20:23], s63 offen lds
  s_add_u32 s63, s70, 196608
  s_add_u32 m0, s92, 12288
  s_nop 0
  buffer_load_dwordx4 v16, s[20:23], s63 offen lds
  s_add_u32 s63, s70, 212992
  s_add_u32 m0, s92, 13312
  s_nop 0
  buffer_load_dwordx4 v17, s[20:23], s63 offen lds
  s_add_u32 s63, s70, 229376
  s_add_u32 m0, s92, 14336
  s_nop 0
  buffer_load_dwordx4 v18, s[20:23], s63 offen lds
  s_add_u32 s63, s70, 245760
  s_add_u32 m0, s92, 15360
  s_nop 0
  buffer_load_dwordx4 v19, s[20:23], s63 offen lds
  s_add_u32 s63, s71, 0
  s_add_u32 m0, s92, 16384
  s_nop 0
  buffer_load_dwordx4 v16, s[20:23], s63 offen lds
  s_add_u32 s63, s71, 16384
  s_add_u32 m0, s92, 17408
  s_nop 0
  buffer_load_dwordx4 v17, s[20:23], s63 offen lds
  s_add_u32 s63, s71, 32768
  s_add_u32 m0, s92, 18432
  s_nop 0
  buffer_load_dwordx4 v18, s[20:23], s63 offen lds
  s_add_u32 s63, s71, 49152
  s_add_u32 m0, s92, 19456
  s_nop 0
  buffer_load_dwordx4 v19, s[20:23], s63 offen lds
  s_add_u32 s63, s71, 65536
  s_add_u32 m0, s92, 20480
  s_nop 0
  buffer_load_dwordx4 v16, s[20:23], s63 offen lds
  s_add_u32 s63, s71, 81920
  s_add_u32 m0, s92, 21504
  s_nop 0
  buffer_load_dwordx4 v17, s[20:23], s63 offen lds
  s_add_u32 s63, s71, 98304
  s_add_u32 m0, s92, 22528
  s_nop 0
  buffer_load_dwordx4 v18, s[20:23], s63 offen lds
  s_add_u32 s63, s71, 114688
  s_add_u32 m0, s92, 23552
  s_nop 0
  buffer_load_dwordx4 v19, s[20:23], s63 offen lds
  s_add_u32 s63, s71, 131072
  s_add_u32 m0, s92, 24576
  s_nop 0
  buffer_load_dwordx4 v16, s[20:23], s63 offen lds
  s_add_u32 s63, s71, 147456
  s_add_u32 m0, s92, 25600
  s_nop 0
  buffer_load_dwordx4 v17, s[20:23], s63 offen lds
  s_add_u32 s63, s71, 163840
  s_add_u32 m0, s92, 26624
  s_nop 0
  buffer_load_dwordx4 v18, s[20:23], s63 offen lds
  s_add_u32 s63, s71, 180224
  s_add_u32 m0, s92, 27648
  s_nop 0
  buffer_load_dwordx4 v19, s[20:23], s63 offen lds
  s_add_u32 s63, s71, 196608
  s_add_u32 m0, s92, 28672
  s_nop 0
  buffer_load_dwordx4 v16, s[20:23], s63 offen lds
  s_add_u32 s63, s71, 212992
  s_add_u32 m0, s92, 29696
  s_nop 0
  buffer_load_dwordx4 v17, s[20:23], s63 offen lds
  s_add_u32 s63, s71, 229376
  s_add_u32 m0, s92, 30720
  s_nop 0
  buffer_load_dwordx4 v18, s[20:23], s63 offen lds
  s_add_u32 s63, s71, 245760
  s_add_u32 m0, s92, 31744
  s_nop 0
  buffer_load_dwordx4 v19, s[20:23], s63 offen lds
  s_lshl_b32 s3, s58, 2
  s_add_u32 s3, s3, 149504
  v_mov_b32 v12, s3
  s_cmp_ge_u32 s58, 2
  s_cbranch_scc1 L_gh_fft
  s_waitcnt vmcnt(16)
  v_mov_b32 v6, 1
  ds_write_b32 v12, v6 offset:16
  s_waitcnt vmcnt(0)
  v_mov_b32 v6, 2
  ds_write_b32 v12, v6 offset:16
  v_lshlrev_b32 v13, 4, v1
  s_lshl_b32 s3, s58, 15
  v_add_u32 v13, s3, v13
  v_add_u32 v14, 65536, v13
  s_mov_b32 s98, 0
L_fr_1030:
  ds_read_b32 v5, v12 offset:0
  s_waitcnt lgkmcnt(0)
  v_readfirstlane_b32 s63, v5
  s_add_u32 s98, s98, 1
  s_cmp_gt_u32 s98, 0x100000
  s_cbranch_scc1 L_fr_1030_x
  s_cmp_lt_u32 s63, 1
  s_cbranch_scc0 L_fr_1030_x
  s_sleep 1
  s_branch L_fr_1030
L_fr_1030_x:
  ds_write_b128 v13, a[0:3] offset:0
  ds_write_b128 v13, a[4:7] offset:1024
  ds_write_b128 v13, a[8:11] offset:2048
  ds_write_b128 v13, a[12:15] offset:3072
  ds_write_b128 v13, a[16:19] offset:4096
  ds_write_b128 v13, a[20:23] offset:5120
  ds_write_b128 v13, a[24:27] offset:6144
  ds_write_b128 v13, a[28:31] offset:7168
  ds_write_b128 v13, a[32:35] offset:8192
  ds_write_b128 v13, a[36:39] offset:9216
  ds_write_b128 v13, a[40:43] offset:10240
  ds_write_b128 v13, a[44:47] offset:11264
  ds_write_b128 v13, a[48:51] offset:12288
  ds_write_b128 v13, a[52:55] offset:13312
  ds_write_b128 v13, a[56:59] offset:14336
  ds_write_b128 v13, a[60:63] offset:15360
  v_mov_b32 v6, 3
  s_waitcnt lgkmcnt(0)
  ds_write_b32 v12, v6 offset:16
  s_add_u32 s63, s69, 256
  buffer_load_dwordx4 a[0:3], v120, s[20:23], s63 offen
  s_add_u32 s63, s69, 16640
  buffer_load_dwordx4 a[4:7], v121, s[20:23], s63 offen
  s_add_u32 s63, s69, 33024
  buffer_load_dwordx4 a[8:11], v122, s[20:23], s63 offen
  s_add_u32 s63, s69, 49408
  buffer_load_dwordx4 a[12:15], v123, s[20:23], s63 offen
  s_add_u32 s63, s69, 65792
  buffer_load_dwordx4 a[16:19], v120, s[20:23], s63 offen
  s_add_u32 s63, s69, 82176
  buffer_load_dwordx4 a[20:23], v121, s[20:23], s63 offen
  s_add_u32 s63, s69, 98560
  buffer_load_dwordx4 a[24:27], v122, s[20:23], s63 offen
  s_add_u32 s63, s69, 114944
  buffer_load_dwordx4 a[28:31], v123, s[20:23], s63 offen
  s_add_u32 s63, s69, 131328
  buffer_load_dwordx4 a[32:35], v120, s[20:23], s63 offen
  s_add_u32 s63, s69, 147712
  buffer_load_dwordx4 a[36:39], v121, s[20:23], s63 offen
  s_add_u32 s63, s69, 164096
  buffer_load_dwordx4 a[40:43], v122, s[20:23], s63 offen
  s_add_u32 s63, s69, 180480
  buffer_load_dwordx4 a[44:47], v123, s[20:23], s63 offen
  s_add_u32 s63, s69, 196864
  buffer_load_dwordx4 a[48:51], v120, s[20:23], s63 offen
  s_add_u32 s63, s69, 213248
  buffer_load_dwordx4 a[52:55], v121, s[20:23], s63 offen
  s_add_u32 s63, s69, 229632
  buffer_load_dwordx4 a[56:59], v122, s[20:23], s63 offen
  s_add_u32 s63, s69, 246016
  buffer_load_dwordx4 a[60:63], v123, s[20:23], s63 offen
  s_mov_b32 s98, 0
L_fr_1031:
  ds_read_b32 v5, v12 offset:8
  s_waitcnt lgkmcnt(0)
  v_readfirstlane_b32 s63, v5
  s_add_u32 s98, s98, 1
  s_cmp_gt_u32 s98, 0x100000
  s_cbranch_scc1 L_fr_1031_x
  s_cmp_lt_u32 s63, 1
  s_cbranch_scc0 L_fr_1031_x
  s_sleep 1
  s_branch L_fr_1031
L_fr_1031_x:
  ds_write_b128 v14, v[32:35] offset:0
  ds_write_b128 v14, v[36:39] offset:1024
  ds_write_b128 v14, v[40:43] offset:2048
  ds_write_b128 v14, v[44:47] offset:3072
  ds_write_b128 v14, v[48:51] offset:4096
  ds_write_b128 v14, v[52:55] offset:5120
  ds_write_b128 v14, v[56:59] offset:6144
  ds_write_b128 v14, v[60:63] offset:7168
  ds_write_b128 v14, v[64:67] offset:8192
  ds_write_b128 v14, v[68:71] offset:9216
  ds_write_b128 v14, v[72:75] offset:10240
  ds_write_b128 v14, v[76:79] offset:11264
  ds_write_b128 v14, v[80:83] offset:12288
  ds_write_b128 v14, v[84:87] offset:13312
  ds_write_b128 v14, v[88:91] offset:14336
  ds_write_b128 v14, v[92:95] offset:15360
  v_mov_b32 v6, 3
  s_waitcnt lgkmcnt(0)
  ds_write_b32 v12, v6 offset:24
  s_mov_b32 s98, 0
L_fr_1032:
  ds_read_b32 v5, v12 offset:0
  s_waitcnt lgkmcnt(0)
  v_readfirstlane_b32 s63, v5
  s_add_u32 s98, s98, 1
  s_cmp_gt_u32 s98, 0x100000
  s_cbranch_scc1 L_fr_1032_x
  s_cmp_lt_u32 s63, 2
  s_cbranch_scc0 L_fr_1032_x
  s_sleep 1
  s_branch L_fr_1032
L_fr_1032_x:
  ds_write_b128 v13, a[64:67] offset:16384
  ds_write_b128 v13, a[68:71] offset:17408
  ds_write_b128 v13, a[72:75] offset:18432
  ds_write_b128 v13, a[76:79] offset:19456
  ds_write_b128 v13, a[80:83] offset:20480
  ds_write_b128 v13, a[84:87] offset:21504
  ds_write_b128 v13, a[88:91] offset:22528
  ds_write_b128 v13, a[92:95] offset:23552
  ds_write_b128 v13, a[96:99] offset:24576
  ds_write_b128 v13, a[100:103] offset:25600
  ds_write_b128 v13, a[104:107] offset:26624
  ds_write_b128 v13, a[108:111] offset:27648
  ds_write_b128 v13, a[112:115] offset:28672
  ds_write_b128 v13, a[116:119] offset:29696
  ds_write_b128 v13, a[120:123] offset:30720
  ds_write_b128 v13, a[124:127] offset:31744
  v_mov_b32 v6, 4
  s_waitcnt lgkmcnt(0)
  ds_write_b32 v12, v6 offset:16
  s_mov_b32 s98, 0
L_fr_1033:
  ds_read_b32 v5, v12 offset:8
  s_waitcnt lgkmcnt(0)
  v_readfirstlane_b32 s63, v5
  s_add_u32 s98, s98, 1
  s_cmp_gt_u32 s98, 0x100000
  s_cbranch_scc1 L_fr_1033_x
  s_cmp_lt_u32 s63, 2
  s_cbranch_scc0 L_fr_1033_x
  s_sleep 1
  s_branch L_fr_1033
L_fr_1033_x:
  s_waitcnt vmcnt(0)
  ds_write_b128 v14, a[0:3] offset:16384
  ds_write_b128 v14, a[4:7] offset:17408
  ds_write_b128 v14, a[8:11] offset:18432
  ds_write_b128 v14, a[12:15] offset:19456
  ds_write_b128 v14, a[16:19] offset:20480
  ds_write_b128 v14, a[20:23] offset:21504
  ds_write_b128 v14, a[24:27] offset:22528
  ds_write_b128 v14, a[28:31] offset:23552
  ds_write_b128 v14, a[32:35] offset:24576
  ds_write_b128 v14, a[36:39] offset:25600
  ds_write_b128 v14, a[40:43] offset:26624
  ds_write_b128 v14, a[44:47] offset:27648
  ds_write_b128 v14, a[48:51] offset:28672
  ds_write_b128 v14, a[52:55] offset:29696
  ds_write_b128 v14, a[56:59] offset:30720
  ds_write_b128 v14, a[60:63] offset:31744
  v_mov_b32 v6, 4
  s_waitcnt lgkmcnt(0)
  ds_write_b32 v12, v6 offset:24
  s_branch L_gh_done
L_gh_fft:
  s_waitcnt vmcnt(16)
  v_mov_b32 v6, 1
  ds_write_b32 v12, v6 offset:16
  s_waitcnt vmcnt(0)
  v_mov_b32 v6, 2
  ds_write_b32 v12, v6 offset:16
  s_setprio 3
  v_accvgpr_read_b32 v10, a60
  v_accvgpr_read_b32 v11, a61
  s_lshl_b32 s3, s45, 5
  v_add_u32 v12, s3, v1
  v_lshlrev_b32 v12, 7, v12
  v_add_u32 v12, 0x800c, v12
  s_mov_b32 s98, 0
  s_mov_b32 exec_lo, 0xffffffff
  s_mov_b32 exec_hi, 0x0
L_poll_1034:
  buffer_load_dword v16, v12, s[28:31], 0 offen sc1
  s_waitcnt vmcnt(0)
  v_cmp_ne_u32 vcc, s49, v16
  s_add_u32 s98, s98, 1
  s_cmp_gt_u32 s98, 0x8000
  s_cbranch_scc1 L_poll_1034_x
  s_cbranch_vccz L_poll_1034_x
  s_sleep 2
  s_branch L_poll_1034
L_poll_1034_x:
  s_mov_b64 exec, -1
  v_lshlrev_b32 v13, 4, v1
  s_lshl_b32 s3, s50, 13
  s_add_u32 s3, s3, 0x400000
  buffer_load_dwordx4 v[32:35], v13, s[28:31], s3 offen sc1
  s_add_u32 s3, s3, 1024
  buffer_load_dwordx4 v[36:39], v13, s[28:31], s3 offen sc1
  s_add_u32 s3, s3, 1024
  buffer_load_dwordx4 v[40:43], v13, s[28:31], s3 offen sc1
  s_add_u32 s3, s3, 1024
  buffer_load_dwordx4 v[44:47], v13, s[28:31], s3 offen sc1
  s_add_u32 s3, s3, 1024
  buffer_load_dwordx4 v[48:51], v13, s[28:31], s3 offen sc1
  s_add_u32 s3, s3, 1024
  buffer_load_dwordx4 v[52:55], v13, s[28:31], s3 offen sc1
  s_add_u32 s3, s3, 1024
  buffer_load_dwordx4 v[56:59], v13, s[28:31], s3 offen sc1
  s_add_u32 s3, s3, 1024
  buffer_load_dwordx4 v[60:63], v13, s[28:31], s3 offen sc1
  s_sub_u32 s90, s58, 2
  s_lshl_b32 s91, s90, 13
  s_add_u32 s91, s91, 131072
  v_add_u32 v14, s91, v13
  v_bfe_u32 v7, v1, 2, 2
  v_lshl_add_u32 v7, v3, 3, v7
  v_lshlrev_b32 v7, 7, v7
  v_bfe_u32 v8, v1, 4, 1
  v_lshlrev_b32 v8, 5, v8
  v_and_b32 v9, 1, v1
  v_lshl_add_u32 v8, v9, 4, v8
  v_bfe_u32 v9, v1, 1, 1
  v_lshl_add_u32 v8, v9, 3, v8
  v_add_u32 v7, v7, v8
  v_add_u32 v15, s91, v7
  s_waitcnt vmcnt(0)
  ds_write_b128 v14, v[32:35] offset:0
  ds_write_b128 v14, v[36:39] offset:1024
  ds_write_b128 v14, v[40:43] offset:2048
  ds_write_b128 v14, v[44:47] offset:3072
  ds_write_b128 v14, v[48:51] offset:4096
  ds_write_b128 v14, v[52:55] offset:5120
  ds_write_b128 v14, v[56:59] offset:6144
  ds_write_b128 v14, v[60:63] offset:7168
  v_mul_f32 v12, 0x3a000000, v10
  v_mul_f32 v13, v12, v11
  s_waitcnt lgkmcnt(0)
  ds_read_b64_tr_b16 v[16:17], v15 offset:0
  ds_read_b64_tr_b16 v[18:19], v15 offset:512
  ds_read_b64_tr_b16 v[20:21], v15 offset:2048
  ds_read_b64_tr_b16 v[22:23], v15 offset:2560
  ds_read_b64_tr_b16 v[24:25], v15 offset:4096
  ds_read_b64_tr_b16 v[26:27], v15 offset:4608
  ds_read_b64_tr_b16 v[28:29], v15 offset:6144
  ds_read_b64_tr_b16 v[30:31], v15 offset:6656
  v_mov_b32 v120, v13
  v_fmamk_f32 v121, v12, 0x3f800000, v13
  v_fmamk_f32 v122, v12, 0x40000000, v13
  v_fmamk_f32 v123, v12, 0x40400000, v13
  v_fmamk_f32 v124, v12, 0x40800000, v13
  v_fmamk_f32 v125, v12, 0x40a00000, v13
  v_fmamk_f32 v126, v12, 0x40c00000, v13
  v_fmamk_f32 v127, v12, 0x40e00000, v13
  v_cos_f32 v64, v120
  v_sin_f32 v80, v120
  v_cos_f32 v65, v121
  v_sin_f32 v81, v121
  v_cos_f32 v66, v122
  v_sin_f32 v82, v122
  v_cos_f32 v67, v123
  v_sin_f32 v83, v123
  v_cos_f32 v68, v124
  v_sin_f32 v84, v124
  v_cos_f32 v69, v125
  v_sin_f32 v85, v125
  v_cos_f32 v70, v126
  v_sin_f32 v86, v126
  v_cos_f32 v71, v127
  v_sin_f32 v87, v127
  v_fmamk_f32 v120, v12, 0x41800000, v13
  v_fmamk_f32 v121, v12, 0x41880000, v13
  v_fmamk_f32 v122, v12, 0x41900000, v13
  v_fmamk_f32 v123, v12, 0x41980000, v13
  v_fmamk_f32 v124, v12, 0x41a00000, v13
  v_fmamk_f32 v125, v12, 0x41a80000, v13
  v_fmamk_f32 v126, v12, 0x41b00000, v13
  v_fmamk_f32 v127, v12, 0x41b80000, v13
  v_cos_f32 v72, v120
  v_sin_f32 v88, v120
  v_cos_f32 v73, v121
  v_sin_f32 v89, v121
  v_cos_f32 v74, v122
  v_sin_f32 v90, v122
  v_cos_f32 v75, v123
  v_sin_f32 v91, v123
  v_cos_f32 v76, v124
  v_sin_f32 v92, v124
  v_cos_f32 v77, v125
  v_sin_f32 v93, v125
  v_cos_f32 v78, v126
  v_sin_f32 v94, v126
  v_cos_f32 v79, v127
  v_sin_f32 v95, v127
  s_waitcnt lgkmcnt(0)
  v_mfma_f32_32x32x16_bf16 v[32:47], v[16:19], a[0:3], 0
  v_mfma_f32_32x32x16_bf16 v[48:63], v[16:19], a[8:11], 0
  v_mfma_f32_32x32x16_bf16 v[32:47], v[20:23], a[4:7], v[32:47]
  v_mfma_f32_32x32x16_bf16 v[48:63], v[20:23], a[12:15], v[48:63]
  v_mfma_f32_32x32x16_bf16 v[32:47], v[24:27], a[16:19], v[32:47]
  v_mfma_f32_32x32x16_bf16 v[48:63], v[24:27], a[0:3], v[48:63]
  v_mfma_f32_32x32x16_bf16 v[32:47], v[28:31], a[20:23], v[32:47]
  v_mfma_f32_32x32x16_bf16 v[48:63], v[28:31], a[4:7], v[48:63]
  s_nop 11
  v_mul_f32 v96, v48, v80
  v_mul_f32 v98, v32, v80
  v_fmac_f32 v96, v32, v64
  v_fma_f32 v98, v48, v64, -v98
  v_mul_f32 v97, v49, v81
  v_mul_f32 v99, v33, v81
  v_fmac_f32 v97, v33, v65
  v_fma_f32 v99, v49, v65, -v99
  v_cvt_pk_bf16_f32 v104, v96, v97
  v_cvt_pk_bf16_f32 v112, v98, v99
  v_mul_f32 v100, v50, v82
  v_mul_f32 v102, v34, v82
  v_fmac_f32 v100, v34, v66
  v_fma_f32 v102, v50, v66, -v102
  v_mul_f32 v101, v51, v83
  v_mul_f32 v103, v35, v83
  v_fmac_f32 v101, v35, v67
  v_fma_f32 v103, v51, v67, -v103
  v_cvt_pk_bf16_f32 v105, v100, v101
  v_cvt_pk_bf16_f32 v113, v102, v103
  v_mul_f32 v96, v52, v84
  v_mul_f32 v98, v36, v84
  v_fmac_f32 v96, v36, v68
  v_fma_f32 v98, v52, v68, -v98
  v_mul_f32 v97, v53, v85
  v_mul_f32 v99, v37, v85
  v_fmac_f32 v97, v37, v69
  v_fma_f32 v99, v53, v69, -v99
  v_cvt_pk_bf16_f32 v106, v96, v97
  v_cvt_pk_bf16_f32 v114, v98, v99
  v_mul_f32 v100, v54, v86
  v_mul_f32 v102, v38, v86
  v_fmac_f32 v100, v38, v70
  v_fma_f32 v102, v54, v70, -v102
  v_mul_f32 v101, v55, v87
  v_mul_f32 v103, v39, v87
  v_fmac_f32 v101, v39, v71
  v_fma_f32 v103, v55, v71, -v103
  v_cvt_pk_bf16_f32 v107, v100, v101
  v_cvt_pk_bf16_f32 v115, v102, v103
  v_mul_f32 v96, v56, v88
  v_mul_f32 v98, v40, v88
  v_fmac_f32 v96, v40, v72
  v_fma_f32 v98, v56, v72, -v98
  v_mul_f32 v97, v57, v89
  v_mul_f32 v99, v41, v89
  v_fmac_f32 v97, v41, v73
  v_fma_f32 v99, v57, v73, -v99
  v_cvt_pk_bf16_f32 v108, v96, v97
  v_cvt_pk_bf16_f32 v116, v98, v99
  v_mul_f32 v100, v58, v90
  v_mul_f32 v102, v42, v90
  v_fmac_f32 v100, v42, v74
  v_fma_f32 v102, v58, v74, -v102
  v_mul_f32 v101, v59, v91
  v_mul_f32 v103, v43, v91
  v_fmac_f32 v101, v43, v75
  v_fma_f32 v103, v59, v75, -v103
  v_cvt_pk_bf16_f32 v109, v100, v101
  v_cvt_pk_bf16_f32 v117, v102, v103
  v_mul_f32 v96, v60, v92
  v_mul_f32 v98, v44, v92
  v_fmac_f32 v96, v44, v76
  v_fma_f32 v98, v60, v76, -v98
  v_mul_f32 v97, v61, v93
  v_mul_f32 v99, v45, v93
  v_fmac_f32 v97, v45, v77
  v_fma_f32 v99, v61, v77, -v99
  v_cvt_pk_bf16_f32 v110, v96, v97
  v_cvt_pk_bf16_f32 v118, v98, v99
  v_mul_f32 v100, v62, v94
  v_mul_f32 v102, v46, v94
  v_fmac_f32 v100, v46, v78
  v_fma_f32 v102, v62, v78, -v102
  v_mul_f32 v101, v63, v95
  v_mul_f32 v103, v47, v95
  v_fmac_f32 v101, v47, v79
  v_fma_f32 v103, v63, v79, -v103
  v_cvt_pk_bf16_f32 v111, v100, v101
  v_cvt_pk_bf16_f32 v119, v102, v103
  v_mfma_f32_32x32x16_bf16 a[64:79], v[104:107], a[24:27], 0
  v_mfma_f32_32x32x16_bf16 a[64:79], v[108:111], a[28:31], a[64:79]
  v_mfma_f32_32x32x16_bf16 a[64:79], v[112:115], a[32:35], a[64:79]
  v_mfma_f32_32x32x16_bf16 a[64:79], v[116:119], a[36:39], a[64:79]
  v_mul_f32 v12, 0x3a000000, v10
  v_mul_f32 v13, v12, v11
  ds_read_b64_tr_b16 v[16:17], v15 offset:64
  ds_read_b64_tr_b16 v[18:19], v15 offset:576
  ds_read_b64_tr_b16 v[20:21], v15 offset:2112
  ds_read_b64_tr_b16 v[22:23], v15 offset:2624
  ds_read_b64_tr_b16 v[24:25], v15 offset:4160
  ds_read_b64_tr_b16 v[26:27], v15 offset:4672
  ds_read_b64_tr_b16 v[28:29], v15 offset:6208
  ds_read_b64_tr_b16 v[30:31], v15 offset:6720
  v_fmamk_f32 v120, v12, 0x42000000, v13
  v_fmamk_f32 v121, v12, 0x42040000, v13
  v_fmamk_f32 v122, v12, 0x42080000, v13
  v_fmamk_f32 v123, v12, 0x420c0000, v13
  v_fmamk_f32 v124, v12, 0x42100000, v13
  v_fmamk_f32 v125, v12, 0x42140000, v13
  v_fmamk_f32 v126, v12, 0x42180000, v13
  v_fmamk_f32 v127, v12, 0x421c0000, v13
  v_cos_f32 v64, v120
  v_sin_f32 v80, v120
  v_cos_f32 v65, v121
  v_sin_f32 v81, v121
  v_cos_f32 v66, v122
  v_sin_f32 v82, v122
  v_cos_f32 v67, v123
  v_sin_f32 v83, v123
  v_cos_f32 v68, v124
  v_sin_f32 v84, v124
  v_cos_f32 v69, v125
  v_sin_f32 v85, v125
  v_cos_f32 v70, v126
  v_sin_f32 v86, v126
  v_cos_f32 v71, v127
  v_sin_f32 v87, v127
  v_fmamk_f32 v120, v12, 0x42400000, v13
  v_fmamk_f32 v121, v12, 0x42440000, v13
  v_fmamk_f32 v122, v12, 0x42480000, v13
  v_fmamk_f32 v123, v12, 0x424c0000, v13
  v_fmamk_f32 v124, v12, 0x42500000, v13
  v_fmamk_f32 v125, v12, 0x42540000, v13
  v_fmamk_f32 v126, v12, 0x42580000, v13
  v_fmamk_f32 v127, v12, 0x425c0000, v13
  v_cos_f32 v72, v120
  v_sin_f32 v88, v120
  v_cos_f32 v73, v121
  v_sin_f32 v89, v121
  v_cos_f32 v74, v122
  v_sin_f32 v90, v122
  v_cos_f32 v75, v123
  v_sin_f32 v91, v123
  v_cos_f32 v76, v124
  v_sin_f32 v92, v124
  v_cos_f32 v77, v125
  v_sin_f32 v93, v125
  v_cos_f32 v78, v126
  v_sin_f32 v94, v126
  v_cos_f32 v79, v127
  v_sin_f32 v95, v127
  s_waitcnt lgkmcnt(0)
  v_mfma_f32_32x32x16_bf16 v[32:47], v[16:19], a[0:3], 0
  v_mfma_f32_32x32x16_bf16 v[48:63], v[16:19], a[8:11], 0
  v_mfma_f32_32x32x16_bf16 v[32:47], v[20:23], a[4:7], v[32:47]
  v_mfma_f32_32x32x16_bf16 v[48:63], v[20:23], a[12:15], v[48:63]
  v_mfma_f32_32x32x16_bf16 v[32:47], v[24:27], a[16:19], v[32:47]
  v_mfma_f32_32x32x16_bf16 v[48:63], v[24:27], a[0:3], v[48:63]
  v_mfma_f32_32x32x16_bf16 v[32:47], v[28:31], a[20:23], v[32:47]
  v_mfma_f32_32x32x16_bf16 v[48:63], v[28:31], a[4:7], v[48:63]
  s_nop 11
  v_mul_f32 v96, v48, v80
  v_mul_f32 v98, v32, v80
  v_fmac_f32 v96, v32, v64
  v_fma_f32 v98, v48, v64, -v98
  v_mul_f32 v97, v49, v81
  v_mul_f32 v99, v33, v81
  v_fmac_f32 v97, v33, v65
  v_fma_f32 v99, v49, v65, -v99
  v_cvt_pk_bf16_f32 v104, v96, v97
  v_cvt_pk_bf16_f32 v112, v98, v99
  v_mul_f32 v100, v50, v82
  v_mul_f32 v102, v34, v82
  v_fmac_f32 v100, v34, v66
  v_fma_f32 v102, v50, v66, -v102
  v_mul_f32 v101, v51, v83
  v_mul_f32 v103, v35, v83
  v_fmac_f32 v101, v35, v67
  v_fma_f32 v103, v51, v67, -v103
  v_cvt_pk_bf16_f32 v105, v100, v101
  v_cvt_pk_bf16_f32 v113, v102, v103
  v_mul_f32 v96, v52, v84
  v_mul_f32 v98, v36, v84
  v_fmac_f32 v96, v36, v68
  v_fma_f32 v98, v52, v68, -v98
  v_mul_f32 v97, v53, v85
  v_mul_f32 v99, v37, v85
  v_fmac_f32 v97, v37, v69
  v_fma_f32 v99, v53, v69, -v99
  v_cvt_pk_bf16_f32 v106, v96, v97
  v_cvt_pk_bf16_f32 v114, v98, v99
  v_mul_f32 v100, v54, v86
  v_mul_f32 v102, v38, v86
  v_fmac_f32 v100, v38, v70
  v_fma_f32 v102, v54, v70, -v102
  v_mul_f32 v101, v55, v87
  v_mul_f32 v103, v39, v87
  v_fmac_f32 v101, v39, v71
  v_fma_f32 v103, v55, v71, -v103
  v_cvt_pk_bf16_f32 v107, v100, v101
  v_cvt_pk_bf16_f32 v115, v102, v103
  v_mul_f32 v96, v56, v88
  v_mul_f32 v98, v40, v88
  v_fmac_f32 v96, v40, v72
  v_fma_f32 v98, v56, v72, -v98
  v_mul_f32 v97, v57, v89
  v_mul_f32 v99, v41, v89
  v_fmac_f32 v97, v41, v73
  v_fma_f32 v99, v57, v73, -v99
  v_cvt_pk_bf16_f32 v108, v96, v97
  v_cvt_pk_bf16_f32 v116, v98, v99
  v_mul_f32 v100, v58, v90
  v_mul_f32 v102, v42, v90
  v_fmac_f32 v100, v42, v74
  v_fma_f32 v102, v58, v74, -v102
  v_mul_f32 v101, v59, v91
  v_mul_f32 v103, v43, v91
  v_fmac_f32 v101, v43, v75
  v_fma_f32 v103, v59, v75, -v103
  v_cvt_pk_bf16_f32 v109, v100, v101
  v_cvt_pk_bf16_f32 v117, v102, v103
  v_mul_f32 v96, v60, v92
  v_mul_f32 v98, v44, v92
  v_fmac_f32 v96, v44, v76
  v_fma_f32 v98, v60, v76, -v98
  v_mul_f32 v97, v61, v93
  v_mul_f32 v99, v45, v93
  v_fmac_f32 v97, v45, v77
  v_fma_f32 v99, v61, v77, -v99
  v_cvt_pk_bf16_f32 v110, v96, v97
  v_cvt_pk_bf16_f32 v118, v98, v99
  v_mul_f32 v100, v62, v94
  v_mul_f32 v102, v46, v94
  v_fmac_f32 v100, v46, v78
  v_fma_f32 v102, v62, v78, -v102
  v_mul_f32 v101, v63, v95
  v_mul_f32 v103, v47, v95
  v_fmac_f32 v101, v47, v79
  v_fma_f32 v103, v63, v79, -v103
  v_cvt_pk_bf16_f32 v111, v100, v101
  v_cvt_pk_bf16_f32 v119, v102, v103
  v_mfma_f32_32x32x16_bf16 a[64:79], v[104:107], a[40:43], a[64:79]
  v_mfma_f32_32x32x16_bf16 a[64:79], v[108:111], a[44:47], a[64:79]
  v_mfma_f32_32x32x16_bf16 a[64:79], v[112:115], a[48:51], a[64:79]
  v_mfma_f32_32x32x16_bf16 a[64:79], v[116:119], a[52:55], a[64:79]
  v_lshlrev_b32 v6, 7, v2
  v_lshl_add_u32 v6, v3, 6, v6
  v_add_u32 v6, s91, v6
  s_nop 8
  ds_write_b128 v6, a[64:67] offset:0
  ds_write_b128 v6, a[68:71] offset:16
  ds_write_b128 v6, a[72:75] offset:32
  ds_write_b128 v6, a[76:79] offset:48
  s_waitcnt lgkmcnt(0)
  ds_read_b128 v[32:35], v14 offset:0
  ds_read_b128 v[36:39], v14 offset:1024
  ds_read_b128 v[40:43], v14 offset:2048
  ds_read_b128 v[44:47], v14 offset:3072
  s_cmp_eq_u32 s50, 0
  s_cselect_b32 s63, 256, s50
  s_lshl_b32 s63, s63, 13
  s_lshl_b32 s3, s90, 12
  s_add_u32 s3, s3, s63
  s_add_u32 s3, s3, 0x900000
  v_lshlrev_b32 v6, 4, v1
  v_lshlrev_b32 v7, 4, v1
  v_sub_u32 v7, 4084, v7
  v_add_u32 v7, s91, v7
  ds_read_b32 v48, v7 offset:12
  ds_read_b32 v49, v7 offset:8
  ds_read_b32 v50, v7 offset:4
  ds_read_b32 v51, v7 offset:0
  v_subrev_u32 v8, 3072, v7
  ds_read_b32 v52, v8 offset:2060
  ds_read_b32 v53, v8 offset:2056
  ds_read_b32 v54, v8 offset:2052
  ds_read_b32 v55, v8 offset:2048
  ds_read_b32 v56, v8 offset:1036
  ds_read_b32 v57, v8 offset:1032
  ds_read_b32 v58, v8 offset:1028
  ds_read_b32 v59, v8 offset:1024
  ds_read_b32 v60, v8 offset:12
  ds_read_b32 v61, v8 offset:8
  ds_read_b32 v62, v8 offset:4
  ds_read_b32 v63, v8 offset:0
  s_waitcnt lgkmcnt(15)
  s_waitcnt lgkmcnt(0)
  buffer_store_dwordx4 v[32:35], v6, s[28:31], s3 offen offset:0 sc1
  buffer_store_dwordx4 v[36:39], v6, s[28:31], s3 offen offset:1024 sc1
  buffer_store_dwordx4 v[40:43], v6, s[28:31], s3 offen offset:2048 sc1
  buffer_store_dwordx4 v[44:47], v6, s[28:31], s3 offen offset:3072 sc1
  s_cmp_eq_u32 s50, 0
  s_cbranch_scc1 L_fft_nomir
  s_sub_u32 s63, 512, s50
  s_lshl_b32 s63, s63, 13
  s_xor_b32 s3, s90, 1
  s_lshl_b32 s3, s3, 12
  s_add_u32 s3, s3, s63
  s_add_u32 s3, s3, 0x900000
  s_mov_b64 exec, -2
  buffer_store_dwordx4 v[48:51], v6, s[28:31], s3 offen sc1
  s_mov_b64 exec, 1
  buffer_store_dword v49, v6, s[28:31], s3 offen offset:4 sc1
  buffer_store_dwordx2 v[50:51], v6, s[28:31], s3 offen offset:8 sc1
  s_mov_b64 exec, -1
  buffer_store_dwordx4 v[52:55], v6, s[28:31], s3 offen offset:1024 sc1
  buffer_store_dwordx4 v[56:59], v6, s[28:31], s3 offen offset:2048 sc1
  buffer_store_dwordx4 v[60:63], v6, s[28:31], s3 offen offset:3072 sc1
  s_lshl_b32 s3, s90, 12
  s_add_u32 s3, s3, s63
  s_add_u32 s3, s3, 0x900000
  s_mov_b64 exec, 1
  buffer_store_dword v32, v6, s[28:31], s3 offen sc1
  s_mov_b64 exec, -1
L_fft_nomir:
  s_setprio 0
  s_waitcnt vmcnt(0)
  s_sub_u32 s90, s58, 2
  s_lshl_b32 s63, s50, 7
  s_add_u32 s63, s63, 0x18000
  s_lshl_b32 s3, s90, 2
  s_add_u32 s63, s63, s3
  v_mov_b32 v5, s49
  v_mov_b32 v6, 0
  s_mov_b64 exec, 1
  buffer_store_dword v5, v6, s[28:31], s63 offen sc1
  s_mov_b64 exec, -1
L_gh_done:
  v_lshrrev_b32 v5, 3, v1
  v_and_b32 v6, 7, v1
  v_bfe_u32 v7, v1, 4, 1
  v_lshlrev_b32 v7, 2, v7
  v_xor_b32 v6, v6, v7
  v_lshlrev_b32 v6, 4, v6
  v_lshl_add_u32 v9, v5, 10, v6
  s_lshl_b32 s3, s45, 7
  v_add_u32 v9, s3, v9
  s_cmp_lg_u32 s58, 2
  s_cbranch_scc1 L_wo_1035
  s_mov_b32 m0, 131072
  s_mov_b32 s63, 458752
  buffer_load_dwordx4 v9, s[24:27], s63 offen lds
  s_mov_b32 m0, 132096
  s_mov_b32 s63, 466944
  buffer_load_dwordx4 v9, s[24:27], s63 offen lds
  s_mov_b32 m0, 133120
  s_mov_b32 s63, 475136
  buffer_load_dwordx4 v9, s[24:27], s63 offen lds
  s_mov_b32 m0, 134144
  s_mov_b32 s63, 483328
  buffer_load_dwordx4 v9, s[24:27], s63 offen lds
  s_mov_b32 m0, 135168
  s_mov_b32 s63, 491520
  buffer_load_dwordx4 v9, s[24:27], s63 offen lds
  s_mov_b32 m0, 136192
  s_mov_b32 s63, 499712
  buffer_load_dwordx4 v9, s[24:27], s63 offen lds
  s_mov_b32 m0, 137216
  s_mov_b32 s63, 507904
  buffer_load_dwordx4 v9, s[24:27], s63 offen lds
  s_mov_b32 m0, 138240
  s_mov_b32 s63, 516096
  buffer_load_dwordx4 v9, s[24:27], s63 offen lds
  s_mov_b32 m0, 150528
  s_mov_b32 s63, 614400
  buffer_load_dwordx4 v9, s[24:27], s63 offen lds
  s_mov_b32 m0, 151552
  s_mov_b32 s63, 622592
  buffer_load_dwordx4 v9, s[24:27], s63 offen lds
  s_mov_b32 m0, 152576
  s_mov_b32 s63, 630784
  buffer_load_dwordx4 v9, s[24:27], s63 offen lds
  s_mov_b32 m0, 153600
  s_mov_b32 s63, 638976
  buffer_load_dwordx4 v9, s[24:27], s63 offen lds
  s_mov_b32 m0, 154624
  s_mov_b32 s63, 647168
  buffer_load_dwordx4 v9, s[24:27], s63 offen lds
  s_mov_b32 m0, 155648
  s_mov_b32 s63, 655360
  buffer_load_dwordx4 v9, s[24:27], s63 offen lds
L_wo_1035:
  s_cmp_lg_u32 s58, 3
  s_cbranch_scc1 L_wo_1036
  s_mov_b32 m0, 139264
  s_mov_b32 s63, 524288
  buffer_load_dwordx4 v9, s[24:27], s63 offen lds
  s_mov_b32 m0, 140288
  s_mov_b32 s63, 532480
  buffer_load_dwordx4 v9, s[24:27], s63 offen lds
  s_mov_b32 m0, 141312
  s_mov_b32 s63, 540672
  buffer_load_dwordx4 v9, s[24:27], s63 offen lds
  s_mov_b32 m0, 142336
  s_mov_b32 s63, 548864
  buffer_load_dwordx4 v9, s[24:27], s63 offen lds
  s_mov_b32 m0, 143360
  s_mov_b32 s63, 557056
  buffer_load_dwordx4 v9, s[24:27], s63 offen lds
  s_mov_b32 m0, 144384
  s_mov_b32 s63, 565248
  buffer_load_dwordx4 v9, s[24:27], s63 offen lds
  s_mov_b32 m0, 145408
  s_mov_b32 s63, 573440
  buffer_load_dwordx4 v9, s[24:27], s63 offen lds
  s_mov_b32 m0, 146432
  s_mov_b32 s63, 581632
  buffer_load_dwordx4 v9, s[24:27], s63 offen lds
  s_mov_b32 m0, 156672
  s_mov_b32 s63, 663552
  buffer_load_dwordx4 v9, s[24:27], s63 offen lds
  s_mov_b32 m0, 157696
  s_mov_b32 s63, 671744
  buffer_load_dwordx4 v9, s[24:27], s63 offen lds
  s_mov_b32 m0, 158720
  s_mov_b32 s63, 679936
  buffer_load_dwordx4 v9, s[24:27], s63 offen lds
  s_mov_b32 m0, 159744
  s_mov_b32 s63, 688128
  buffer_load_dwordx4 v9, s[24:27], s63 offen lds
  s_mov_b32 m0, 160768
  s_mov_b32 s63, 696320
  buffer_load_dwordx4 v9, s[24:27], s63 offen lds
  s_mov_b32 m0, 161792
  s_mov_b32 s63, 704512
  buffer_load_dwordx4 v9, s[24:27], s63 offen lds
  s_mov_b32 m0, 162816
  s_mov_b32 s63, 712704
  buffer_load_dwordx4 v9, s[24:27], s63 offen lds
L_wo_1036:
  s_barrier
  s_cmp_lg_u32 s58, 0
  s_cbranch_scc1 L_wo_1037
  s_mov_b32 m0, 73728
  s_mov_b32 s63, 0
  buffer_load_dwordx4 v9, s[24:27], s63 offen lds
  s_mov_b32 m0, 74752
  s_mov_b32 s63, 8192
  buffer_load_dwordx4 v9, s[24:27], s63 offen lds
  s_mov_b32 m0, 75776
  s_mov_b32 s63, 16384
  buffer_load_dwordx4 v9, s[24:27], s63 offen lds
  s_mov_b32 m0, 76800
  s_mov_b32 s63, 24576
  buffer_load_dwordx4 v9, s[24:27], s63 offen lds
  s_mov_b32 m0, 77824
  s_mov_b32 s63, 32768
  buffer_load_dwordx4 v9, s[24:27], s63 offen lds
  s_mov_b32 m0, 78848
  s_mov_b32 s63, 40960
  buffer_load_dwordx4 v9, s[24:27], s63 offen lds
  s_mov_b32 m0, 79872
  s_mov_b32 s63, 49152
  buffer_load_dwordx4 v9, s[24:27], s63 offen lds
  s_mov_b32 m0, 80896
  s_mov_b32 s63, 57344
  buffer_load_dwordx4 v9, s[24:27], s63 offen lds
  s_mov_b32 m0, 81920
  s_mov_b32 s63, 65536
  buffer_load_dwordx4 v9, s[24:27], s63 offen lds
  s_mov_b32 m0, 82944
  s_mov_b32 s63, 73728
  buffer_load_dwordx4 v9, s[24:27], s63 offen lds
  s_mov_b32 m0, 83968
  s_mov_b32 s63, 81920
  buffer_load_dwordx4 v9, s[24:27], s63 offen lds
  s_mov_b32 m0, 84992
  s_mov_b32 s63, 90112
  buffer_load_dwordx4 v9, s[24:27], s63 offen lds
  s_mov_b32 m0, 86016
  s_mov_b32 s63, 98304
  buffer_load_dwordx4 v9, s[24:27], s63 offen lds
  s_mov_b32 m0, 87040
  s_mov_b32 s63, 106496
  buffer_load_dwordx4 v9, s[24:27], s63 offen lds
  s_mov_b32 m0, 88064
  s_mov_b32 s63, 114688
  buffer_load_dwordx4 v9, s[24:27], s63 offen lds
L_wo_1037:
  s_cmp_lg_u32 s58, 1
  s_cbranch_scc1 L_wo_1038
  s_mov_b32 m0, 89088
  s_mov_b32 s63, 122880
  buffer_load_dwordx4 v9, s[24:27], s63 offen lds
  s_mov_b32 m0, 90112
  s_mov_b32 s63, 131072
  buffer_load_dwordx4 v9, s[24:27], s63 offen lds
  s_mov_b32 m0, 91136
  s_mov_b32 s63, 139264
  buffer_load_dwordx4 v9, s[24:27], s63 offen lds
  s_mov_b32 m0, 92160
  s_mov_b32 s63, 147456
  buffer_load_dwordx4 v9, s[24:27], s63 offen lds
  s_mov_b32 m0, 93184
  s_mov_b32 s63, 155648
  buffer_load_dwordx4 v9, s[24:27], s63 offen lds
  s_mov_b32 m0, 94208
  s_mov_b32 s63, 163840
  buffer_load_dwordx4 v9, s[24:27], s63 offen lds
  s_mov_b32 m0, 95232
  s_mov_b32 s63, 172032
  buffer_load_dwordx4 v9, s[24:27], s63 offen lds
  s_mov_b32 m0, 96256
  s_mov_b32 s63, 180224
  buffer_load_dwordx4 v9, s[24:27], s63 offen lds
  s_mov_b32 m0, 97280
  s_mov_b32 s63, 188416
  buffer_load_dwordx4 v9, s[24:27], s63 offen lds
  s_mov_b32 m0, 98304
  s_mov_b32 s63, 196608
  buffer_load_dwordx4 v9, s[24:27], s63 offen lds
  s_mov_b32 m0, 99328
  s_mov_b32 s63, 204800
  buffer_load_dwordx4 v9, s[24:27], s63 offen lds
  s_mov_b32 m0, 100352
  s_mov_b32 s63, 212992
  buffer_load_dwordx4 v9, s[24:27], s63 offen lds
  s_mov_b32 m0, 101376
  s_mov_b32 s63, 221184
  buffer_load_dwordx4 v9, s[24:27], s63 offen lds
  s_mov_b32 m0, 102400
  s_mov_b32 s63, 229376
  buffer_load_dwordx4 v9, s[24:27], s63 offen lds
  s_mov_b32 m0, 103424
  s_mov_b32 s63, 237568
  buffer_load_dwordx4 v9, s[24:27], s63 offen lds
L_wo_1038:
  s_cmp_lg_u32 s58, 2
  s_cbranch_scc1 L_wo_1039
  s_mov_b32 m0, 104448
  s_mov_b32 s63, 245760
  buffer_load_dwordx4 v9, s[24:27], s63 offen lds
  s_mov_b32 m0, 105472
  s_mov_b32 s63, 253952
  buffer_load_dwordx4 v9, s[24:27], s63 offen lds
  s_mov_b32 m0, 106496
  s_mov_b32 s63, 262144
  buffer_load_dwordx4 v9, s[24:27], s63 offen lds
  s_mov_b32 m0, 107520
  s_mov_b32 s63, 270336
  buffer_load_dwordx4 v9, s[24:27], s63 offen lds
  s_mov_b32 m0, 108544
  s_mov_b32 s63, 278528
  buffer_load_dwordx4 v9, s[24:27], s63 offen lds
  s_mov_b32 m0, 109568
  s_mov_b32 s63, 286720
  buffer_load_dwordx4 v9, s[24:27], s63 offen lds
  s_mov_b32 m0, 110592
  s_mov_b32 s63, 294912
  buffer_load_dwordx4 v9, s[24:27], s63 offen lds
  s_mov_b32 m0, 111616
  s_mov_b32 s63, 303104
  buffer_load_dwordx4 v9, s[24:27], s63 offen lds
  s_mov_b32 m0, 112640
  s_mov_b32 s63, 311296
  buffer_load_dwordx4 v9, s[24:27], s63 offen lds
  s_mov_b32 m0, 113664
  s_mov_b32 s63, 319488
  buffer_load_dwordx4 v9, s[24:27], s63 offen lds
  s_mov_b32 m0, 114688
  s_mov_b32 s63, 327680
  buffer_load_dwordx4 v9, s[24:27], s63 offen lds
  s_mov_b32 m0, 115712
  s_mov_b32 s63, 335872
  buffer_load_dwordx4 v9, s[24:27], s63 offen lds
  s_mov_b32 m0, 116736
  s_mov_b32 s63, 344064
  buffer_load_dwordx4 v9, s[24:27], s63 offen lds
  s_mov_b32 m0, 117760
  s_mov_b32 s63, 352256
  buffer_load_dwordx4 v9, s[24:27], s63 offen lds
  s_mov_b32 m0, 118784
  s_mov_b32 s63, 360448
  buffer_load_dwordx4 v9, s[24:27], s63 offen lds
L_wo_1039:
  s_cmp_lg_u32 s58, 3
  s_cbranch_scc1 L_wo_1040
  s_mov_b32 m0, 119808
  s_mov_b32 s63, 368640
  buffer_load_dwordx4 v9, s[24:27], s63 offen lds
  s_mov_b32 m0, 120832
  s_mov_b32 s63, 376832
  buffer_load_dwordx4 v9, s[24:27], s63 offen lds
  s_mov_b32 m0, 121856
  s_mov_b32 s63, 385024
  buffer_load_dwordx4 v9, s[24:27], s63 offen lds
  s_mov_b32 m0, 122880
  s_mov_b32 s63, 393216
  buffer_load_dwordx4 v9, s[24:27], s63 offen lds
  s_mov_b32 m0, 123904
  s_mov_b32 s63, 401408
  buffer_load_dwordx4 v9, s[24:27], s63 offen lds
  s_mov_b32 m0, 124928
  s_mov_b32 s63, 409600
  buffer_load_dwordx4 v9, s[24:27], s63 offen lds
  s_mov_b32 m0, 125952
  s_mov_b32 s63, 417792
  buffer_load_dwordx4 v9, s[24:27], s63 offen lds
  s_mov_b32 m0, 126976
  s_mov_b32 s63, 425984
  buffer_load_dwordx4 v9, s[24:27], s63 offen lds
  s_mov_b32 m0, 128000
  s_mov_b32 s63, 434176
  buffer_load_dwordx4 v9, s[24:27], s63 offen lds
  s_mov_b32 m0, 129024
  s_mov_b32 s63, 442368
  buffer_load_dwordx4 v9, s[24:27], s63 offen lds
  s_mov_b32 m0, 130048
  s_mov_b32 s63, 450560
  buffer_load_dwordx4 v9, s[24:27], s63 offen lds
  s_mov_b32 m0, 147456
  s_mov_b32 s63, 589824
  buffer_load_dwordx4 v9, s[24:27], s63 offen lds
  s_mov_b32 m0, 148480
  s_mov_b32 s63, 598016
  buffer_load_dwordx4 v9, s[24:27], s63 offen lds
  s_mov_b32 m0, 149504
  s_mov_b32 s63, 606208
  buffer_load_dwordx4 v9, s[24:27], s63 offen lds
L_wo_1040:
  s_barrier
  s_lshr_b32 s63, s58, 1
  s_lshl_b32 s3, s45, 6
  s_lshl_b32 s91, s63, 5
  s_add_u32 s91, s3, s91
  s_and_b32 s90, s58, 1
  s_lshl_b32 s3, s44, 6
  s_lshl_b32 s92, s90, 5
  s_add_u32 s3, s3, s92
  v_add_u32 v41, s3, v4
  v_lshlrev_b32 v42, 10, v41
  v_lshl_add_u32 v42, v3, 4, v42
  s_lshl_b32 s3, s91, 1
  v_add_u32 v42, s3, v42
  buffer_load_dwordx4 v[44:47], v42, s[4:7], 0 offen
  buffer_load_dwordx4 v[48:51], v42, s[4:7], 0 offen offset:32
  s_lshl_b32 s3, s45, 6
  s_lshl_b32 s63, s58, 4
  s_add_u32 s63, s3, s63
  v_add_u32 v5, s63, v1
  v_sub_u32 v6, 512, v5
  v_cmp_lt_u32 vcc, 256, v5
  s_nop 1
  v_cndmask_b32 v6, v5, v6, vcc
  v_and_b32 v6, 255, v6
  v_lshlrev_b32 v43, 7, v6
  v_add_u32 v43, 0x18000, v43
  v_lshrrev_b32 v5, 4, v1
  v_add_u32 v5, s63, v5
  v_and_b32 v6, 15, v1
  v_lshlrev_b32 v6, 4, v6
  v_lshl_add_u32 v56, v5, 13, v6
  v_mov_b32 v7, 0x80000000
  v_cmp_eq_u32 vcc, 0, v5
  s_nop 1
  v_cndmask_b32 v57, v56, v7, vcc
  s_lshl_b32 s92, s44, 8
  s_add_u32 s92, s92, 0x900000
  s_mov_b32 s98, 0
  s_mov_b32 exec_lo, 0xffff
  s_mov_b32 exec_hi, 0x0
L_poll_1041:
  buffer_load_dwordx2 v[60:61], v43, s[28:31], 0 offen sc1
  s_waitcnt vmcnt(0)
  v_cmp_ne_u32 vcc, s49, v60
  v_cmp_ne_u32 s[94:95], s49, v61
  s_nop 0
  s_or_b64 vcc, vcc, s[94:95]
  s_add_u32 s98, s98, 1
  s_cmp_gt_u32 s98, 0x8000
  s_cbranch_scc1 L_poll_1041_x
  s_cbranch_vccz L_poll_1041_x
  s_sleep 2
  s_branch L_poll_1041
L_poll_1041_x:
  s_mov_b64 exec, -1
  buffer_load_dwordx4 v[64:67], v57, s[28:31], s92 offen sc1
  s_add_u32 s92, s92, 32768
  buffer_load_dwordx4 v[68:71], v56, s[28:31], s92 offen sc1
  s_add_u32 s92, s92, 32768
  buffer_load_dwordx4 v[72:75], v56, s[28:31], s92 offen sc1
  s_add_u32 s92, s92, 32768
  buffer_load_dwordx4 v[76:79], v56, s[28:31], s92 offen sc1
  s_waitcnt vmcnt(0)
  s_barrier
  v_lshrrev_b32 v5, 4, v1
  v_and_b32 v6, 15, v1
  v_lshlrev_b32 v6, 4, v6
  v_lshl_add_u32 v5, v5, 8, v6
  s_lshl_b32 s3, s58, 12
  s_add_u32 s3, s3, 40960
  v_add_u32 v5, s3, v5
  s_waitcnt vmcnt(0)
  ds_write_b128 v5, v[64:67] offset:0
  ds_write_b128 v5, v[68:71] offset:1024
  ds_write_b128 v5, v[72:75] offset:2048
  ds_write_b128 v5, v[76:79] offset:3072
  s_waitcnt lgkmcnt(0)
  s_barrier
  v_lshlrev_b32 v10, 4, v1
  s_lshl_b32 s3, s58, 13
  v_add_u32 v11, s3, v10
  s_xor_b32 s3, s58, 2
  s_lshl_b32 s3, s3, 13
  s_add_u32 s3, s3, 4096
  v_add_u32 v12, s3, v10
  ds_read_b128 v[80:83], v11 offset:0
  ds_read_b128 v[84:87], v11 offset:1024
  ds_read_b128 v[88:91], v11 offset:2048
  ds_read_b128 v[92:95], v11 offset:3072
  ds_read_b128 v[96:99], v12 offset:0
  ds_read_b128 v[100:103], v12 offset:1024
  ds_read_b128 v[104:107], v12 offset:2048
  ds_read_b128 v[108:111], v12 offset:3072
  s_lshr_b32 s63, s58, 1
  s_lshl_b32 s3, s63, 13
  s_and_b32 s90, s58, 1
  s_lshl_b32 s90, s90, 7
  s_add_u32 s3, s3, s90
  s_add_u32 s3, s3, 40960
  v_lshlrev_b32 v5, 11, v3
  v_lshl_add_u32 v5, v4, 2, v5
  v_add_u32 v5, s3, v5
  ds_read_b32 v64, v5 offset:0
  ds_read_b32 v65, v5 offset:256
  ds_read_b32 v66, v5 offset:512
  ds_read_b32 v67, v5 offset:768
  ds_read_b32 v68, v5 offset:1024
  ds_read_b32 v69, v5 offset:1280
  ds_read_b32 v70, v5 offset:1536
  ds_read_b32 v71, v5 offset:1792
  ds_read_b32 v72, v5 offset:4096
  ds_read_b32 v73, v5 offset:4352
  ds_read_b32 v74, v5 offset:4608
  ds_read_b32 v75, v5 offset:4864
  ds_read_b32 v76, v5 offset:5120
  ds_read_b32 v77, v5 offset:5376
  ds_read_b32 v78, v5 offset:5632
  ds_read_b32 v79, v5 offset:5888
  s_mov_b32 s96, 0xbfb8aa3b
  s_mov_b32 s97, 0xbfb8aa3b
  s_and_b32 s90, s58, 1
  s_lshl_b32 s3, s90, 5
  v_add_u32 v13, s3, v4
  v_and_b32 v14, 7, v13
  s_lshr_b32 s63, s58, 1
  s_lshl_b32 s3, s63, 2
  v_add_u32 v15, s3, v3
  v_xor_b32 v14, v14, v15
  v_lshlrev_b32 v14, 4, v14
  v_lshl_add_u32 v14, v13, 7, v14
  v_add_u32 v14, 32768, v14
  s_waitcnt lgkmcnt(0)
  v_pk_add_f32 v[80:81], v[80:81], v[96:97]
  v_pk_add_f32 v[82:83], v[82:83], v[98:99]
  v_pk_add_f32 v[84:85], v[84:85], v[100:101]
  v_pk_add_f32 v[86:87], v[86:87], v[102:103]
  v_pk_add_f32 v[88:89], v[88:89], v[104:105]
  v_pk_add_f32 v[90:91], v[90:91], v[106:107]
  v_pk_add_f32 v[92:93], v[92:93], v[108:109]
  v_pk_add_f32 v[94:95], v[94:95], v[110:111]
  v_pk_mul_f32 v[96:97], v[80:81], s[96:97]
  v_exp_f32 v96, v96
  v_exp_f32 v97, v97
  s_nop 0
  v_pk_add_f32 v[96:97], v[96:97], 1.0 op_sel_hi:[1,0]
  v_rcp_f32 v96, v96
  v_rcp_f32 v97, v97
  s_nop 0
  v_pk_mul_f32 v[80:81], v[80:81], v[96:97]
  v_pk_mul_f32 v[98:99], v[82:83], s[96:97]
  v_exp_f32 v98, v98
  v_exp_f32 v99, v99
  s_nop 0
  v_pk_add_f32 v[98:99], v[98:99], 1.0 op_sel_hi:[1,0]
  v_rcp_f32 v98, v98
  v_rcp_f32 v99, v99
  s_nop 0
  v_pk_mul_f32 v[82:83], v[82:83], v[98:99]
  v_pk_mul_f32 v[100:101], v[84:85], s[96:97]
  v_exp_f32 v100, v100
  v_exp_f32 v101, v101
  s_nop 0
  v_pk_add_f32 v[100:101], v[100:101], 1.0 op_sel_hi:[1,0]
  v_rcp_f32 v100, v100
  v_rcp_f32 v101, v101
  s_nop 0
  v_pk_mul_f32 v[84:85], v[84:85], v[100:101]
  v_pk_mul_f32 v[102:103], v[86:87], s[96:97]
  v_exp_f32 v102, v102
  v_exp_f32 v103, v103
  s_nop 0
  v_pk_add_f32 v[102:103], v[102:103], 1.0 op_sel_hi:[1,0]
  v_rcp_f32 v102, v102
  v_rcp_f32 v103, v103
  s_nop 0
  v_pk_mul_f32 v[86:87], v[86:87], v[102:103]
  v_pk_mul_f32 v[104:105], v[88:89], s[96:97]
  v_exp_f32 v104, v104
  v_exp_f32 v105, v105
  s_nop 0
  v_pk_add_f32 v[104:105], v[104:105], 1.0 op_sel_hi:[1,0]
  v_rcp_f32 v104, v104
  v_rcp_f32 v105, v105
  s_nop 0
  v_pk_mul_f32 v[88:89], v[88:89], v[104:105]
  v_pk_mul_f32 v[106:107], v[90:91], s[96:97]
  v_exp_f32 v106, v106
  v_exp_f32 v107, v107
  s_nop 0
  v_pk_add_f32 v[106:107], v[106:107], 1.0 op_sel_hi:[1,0]
  v_rcp_f32 v106, v106
  v_rcp_f32 v107, v107
  s_nop 0
  v_pk_mul_f32 v[90:91], v[90:91], v[106:107]
  v_pk_mul_f32 v[108:109], v[92:93], s[96:97]
  v_exp_f32 v108, v108
  v_exp_f32 v109, v109
  s_nop 0
  v_pk_add_f32 v[108:109], v[108:109], 1.0 op_sel_hi:[1,0]
  v_rcp_f32 v108, v108
  v_rcp_f32 v109, v109
  s_nop 0
  v_pk_mul_f32 v[92:93], v[92:93], v[108:109]
  v_pk_mul_f32 v[110:111], v[94:95], s[96:97]
  v_exp_f32 v110, v110
  v_exp_f32 v111, v111
  s_nop 0
  v_pk_add_f32 v[110:111], v[110:111], 1.0 op_sel_hi:[1,0]
  v_rcp_f32 v110, v110
  v_rcp_f32 v111, v111
  s_nop 0
  v_pk_mul_f32 v[94:95], v[94:95], v[110:111]
  v_lshlrev_b32 v96, 16, v44
  v_and_b32 v97, 0xffff0000, v44
  v_pk_fma_f32 v[96:97], v[64:65], v[80:81], v[96:97]
  v_cvt_pk_bf16_f32 v112, v96, v97
  v_lshlrev_b32 v98, 16, v45
  v_and_b32 v99, 0xffff0000, v45
  v_pk_fma_f32 v[98:99], v[66:67], v[82:83], v[98:99]
  v_cvt_pk_bf16_f32 v113, v98, v99
  v_lshlrev_b32 v100, 16, v46
  v_and_b32 v101, 0xffff0000, v46
  v_pk_fma_f32 v[100:101], v[68:69], v[84:85], v[100:101]
  v_cvt_pk_bf16_f32 v114, v100, v101
  v_lshlrev_b32 v102, 16, v47
  v_and_b32 v103, 0xffff0000, v47
  v_pk_fma_f32 v[102:103], v[70:71], v[86:87], v[102:103]
  v_cvt_pk_bf16_f32 v115, v102, v103
  v_lshlrev_b32 v104, 16, v48
  v_and_b32 v105, 0xffff0000, v48
  v_pk_fma_f32 v[104:105], v[72:73], v[88:89], v[104:105]
  v_cvt_pk_bf16_f32 v116, v104, v105
  v_lshlrev_b32 v106, 16, v49
  v_and_b32 v107, 0xffff0000, v49
  v_pk_fma_f32 v[106:107], v[74:75], v[90:91], v[106:107]
  v_cvt_pk_bf16_f32 v117, v106, v107
  v_lshlrev_b32 v108, 16, v50
  v_and_b32 v109, 0xffff0000, v50
  v_pk_fma_f32 v[108:109], v[76:77], v[92:93], v[108:109]
  v_cvt_pk_bf16_f32 v118, v108, v109
  v_lshlrev_b32 v110, 16, v51
  v_and_b32 v111, 0xffff0000, v51
  v_pk_fma_f32 v[110:111], v[78:79], v[94:95], v[110:111]
  v_cvt_pk_bf16_f32 v119, v110, v111
  ds_write_b128 v14, v[112:115]
  v_xor_b32 v14, 32, v14
  ds_write_b128 v14, v[116:119]
  s_waitcnt lgkmcnt(0)
  s_barrier
  v_lshrrev_b32 v5, 3, v1
  v_and_b32 v6, 7, v1
  v_xor_b32 v7, v5, v6
  v_lshlrev_b32 v7, 4, v7
  v_lshl_add_u32 v7, v5, 7, v7
  s_lshl_b32 s3, s58, 11
  s_add_u32 s3, s3, 32768
  v_add_u32 v7, s3, v7
  ds_read_b128 v[16:19], v7
  ds_read_b128 v[20:23], v7 offset:1024
  v_lshlrev_b32 v8, 10, v5
  v_lshl_add_u32 v8, v6, 4, v8
  s_lshl_b32 s63, s44, 6
  s_lshl_b32 s3, s58, 4
  s_add_u32 s63, s63, s3
  s_lshl_b32 s63, s63, 10
  s_lshl_b32 s3, s45, 7
  s_add_u32 s63, s63, s3
  s_waitcnt lgkmcnt(0)
  buffer_store_dwordx4 v[16:19], v8, s[32:35], s63 offen sc1
  s_add_u32 s63, s63, 8192
  buffer_store_dwordx4 v[20:23], v8, s[32:35], s63 offen sc1
L_end:
  s_endpgm
.section .rodata,"a"
.p2align 6
.amdhsa_kernel recurrent_scan__spectral_fnet__mixer_gmlp__prompt_kernel
  .amdhsa_next_free_vgpr 256
  .amdhsa_next_free_sgpr 102
  .amdhsa_accum_offset 128
  .amdhsa_group_segment_fixed_size 0
  .amdhsa_kernarg_size 104
  .amdhsa_user_sgpr_count 2
  .amdhsa_user_sgpr_kernarg_segment_ptr 1
  .amdhsa_system_sgpr_workgroup_id_x 1
  .amdhsa_float_denorm_mode_32 3
.end_amdhsa_kernel
```
